```python
import torch

def _softmax(x, axis=-1):
    return torch.softmax(x, dim=axis)

def _gelu(x):
    return torch.nn.functional.gelu(x, approximate='tanh')

def _silu(x):
    return torch.nn.functional.silu(x)

def _sigmoid(x):
    return torch.sigmoid(x)

def _layernorm(x, axis=-1, eps=1e-05):
    m = x.mean(dim=axis, keepdim=True)
    v = x.var(dim=axis, keepdim=True, unbiased=False)
    return (x - m) / torch.sqrt(v + eps)

def _scatter_add(tgt, idx, src, axis=0):
    return tgt.clone().index_add_(axis, idx, src)

def _segment_sum(src, seg, n):
    out = torch.zeros((n,) + src.shape[1:], dtype=src.dtype)
    return out.index_add_(0, seg, src)

def _pad(x, pw):
    flat = tuple((v for pair in reversed(pw) for v in pair))
    return torch.nn.functional.pad(x, flat)
kernel_name = 'standalone__mixer_gmlp__prompt'

def setup_inputs():

    _w = lambda a: (lambda t: t.to(torch.bfloat16) if t.is_floating_point() else t)(torch.as_tensor(a))
    B, S, D, F = (1, 2048, 640, 1536)
    Fh = F // 2
    return {'x': _w((lambda *s: torch.randn(*s, dtype=torch.bfloat16) * 0.05)(B, S, D)), 'w_in': _w((lambda *s: torch.randn(*s, dtype=torch.bfloat16) * 0.4)(D, 2 * Fh)), 'w_sp': _w(0.01 * (lambda *s: torch.randn(*s, dtype=torch.bfloat16) * 0.4)(S, S)), 'b_sp': _w(1.0 + 0.01 * (lambda *s: torch.randn(*s, dtype=torch.bfloat16) * 0.05)(S)), 'w_out': _w((lambda *s: torch.randn(*s, dtype=torch.bfloat16) * 0.05)(Fh, D))}

def reference(x, w_in, w_sp, b_sp, w_out):
    B, S, D = x.shape
    F = w_in.shape[-1]
    Fh = F // 2
    z = _gelu(torch.einsum('bsd,df->bsf', x, w_in))
    z1 = z[..., :Fh].clone()
    z2 = _layernorm(z[..., Fh:], axis=-1)
    g = torch.einsum('ts,bsf->btf', w_sp, z2) + b_sp[None, :, None]
    return torch.einsum('bsf,fd->bsd', z1 * g, w_out)
```

```asm
; @launch grid=(256,1,1) block=(256,1,1) lds=163840
.amdgcn_target "amdgcn-amd-amdhsa--gfx950"
.text
.p2align 12
.globl standalone__mixer_gmlp__prompt_kernel
.p2align 8
.type standalone__mixer_gmlp__prompt_kernel,@function
standalone__mixer_gmlp__prompt_kernel:
    s_cmp_ge_u32 s2, 256
    s_cbranch_scc1 L_end
    s_load_dwordx2 s[4:5], s[0:1], 0
    s_load_dwordx2 s[8:9], s[0:1], 8
    s_load_dwordx2 s[16:17], s[0:1], 32
    s_load_dwordx2 s[24:25], s[0:1], 56
    s_load_dwordx2 s[12:13], s[0:1], 16
    s_load_dwordx2 s[28:29], s[0:1], 24
    s_load_dwordx2 s[20:21], s[0:1], 40
    v_lshrrev_b32 v1, 6, v0
    v_and_b32 v0, 63, v0
    v_readfirstlane_b32 s32, v1
    v_lshlrev_b32 v21, 4, v0
    s_lshr_b32 s37, s2, 3
    s_getpc_b64 s[54:55]
L_pc:
    s_lshl2_add_u32 s36, s37, s32
    s_and_b32 s36, s36, 31
    s_lshl_b32 s36, s36, 10
    s_min_u32 s36, s36, L_last-L_pc-1024
    s_add_u32 s54, s54, s36
    s_addc_u32 s55, s55, 0
    v_mov_b32 v233, s55
    v_add_co_u32 v232, vcc, s54, v21
    s_and_b32 s36, s2, 7
    s_lshr_b32 s92, s37, 2
    v_addc_co_u32 v233, vcc, 0, v233, vcc
    global_load_dwordx4 v[236:239], v[232:233], off
    s_lshr_b32 s94, s36, 1
    s_and_b32 s95, s36, 1
    s_and_b32 s93, s37, 3
    s_lshl3_add_u32 s33, s94, s92
    s_lshl2_add_u32 s34, s95, s93
    s_lshl2_add_u32 s101, s33, s32
    s_and_b32 s36, s92, 3
    s_cmp_gt_u32 s93, s36
    s_subb_u32 s99, s93, 0
    s_cmp_eq_u32 s93, s36
    s_cselect_b32 s71, 1, 0
    s_mul_i32 s36, s92, 5
    s_mul_i32 s37, s99, 5
    s_add_u32 s36, s36, s37
    s_add_u32 s36, s36, s94
    s_lshl1_add_u32 s36, s95, s36
    s_lshr_b32 s37, s92, 2
    s_add_u32 s36, s36, s37
    s_mul_i32 s37, s36, 205
    s_lshr_b32 s37, s37, 11
    s_mul_i32 s37, s37, 10
    s_sub_u32 s36, s36, s37
    s_lshl_b32 s52, s36, 7
    s_mul_i32 s57, s36, 98304
    s_mov_b32 s6, 2621440
    s_mov_b32 s7, 0x20000
    s_mov_b32 s10, 1966080
    s_mov_b32 s11, 0x20000
    s_mul_i32 s40, s32, 24576
    s_add_u32 s40, s40, 65536
    v_lshrrev_b32 v240, 4, v0
    v_and_b32 v2, 7, v0
    v_xor_b32 v1, v2, v240
    v_lshlrev_b32 v13, 4, v1
    v_xor_b32 v14, 64, v13
    v_lshrrev_b32 v3, 3, v0
    s_mul_i32 s36, s101, 20480
    v_mul_u32_u24 v1, 1280, v3
    v_add3_u32 v4, v1, v13, s36
    s_add_u32 s36, s36, 9216
    v_add3_u32 v5, v1, v14, s36
    s_cmp_eq_u32 s71, 0
    s_waitcnt lgkmcnt(0)
    s_load_dword s35, s[24:25], 0
    s_cbranch_scc1 L_worker
    s_lshl1_add_u32 s59, s33, s95
    s_mul_i32 s36, s59, 171
    s_lshr_b32 s36, s36, 9
    s_mul_i32 s37, s36, 3
    s_sub_u32 s37, s59, s37
    s_mul_i32 s61, s37, 20
    s_add_u32 s61, s61, s36
    s_lshl2_add_u32 s36, s36, s32
    s_mul_i32 s36, s36, 24576
    s_lshl_b32 s37, s37, 9
    s_add_u32 s36, s36, s37
    s_lshl_b32 s56, s32, 10
    v_mul_u32_u24 v245, 3072, v3
    v_lshl_add_u32 v245, v2, 4, v245
    s_add_u32 m0, s56, 0
    s_nop 0
    buffer_load_dwordx4 v245, s[8:11], s36 offen offset:0 lds
    s_add_u32 m0, s56, 3968
    s_nop 0
    buffer_load_dwordx4 v245, s[8:11], s36 offen offset:128 lds
    s_add_u32 m0, s56, 7936
    s_nop 0
    buffer_load_dwordx4 v245, s[8:11], s36 offen offset:256 lds
    s_add_u32 m0, s56, 11904
    s_nop 0
    buffer_load_dwordx4 v245, s[8:11], s36 offen offset:384 lds
    s_mov_b32 s18, 983040
    s_mov_b32 s19, 0x20000
    v_lshl_add_u32 v245, v2, 4, v1
    s_lshl2_add_u32 s37, s59, 0
    s_mul_i32 s36, s37, 205
    s_lshr_b32 s36, s36, 11
    s_mul_i32 s36, s36, 39680
    s_lshl_b32 s37, s37, 7
    s_add_u32 s36, s36, s37
    s_mul_i32 s37, s32, 10240
    s_add_u32 m0, s56, 16384
    s_add_u32 s36, s36, s37
    buffer_load_dwordx4 v245, s[16:19], s36 offen lds
    s_lshl2_add_u32 s37, s59, 1
    s_mul_i32 s36, s37, 205
    s_lshr_b32 s36, s36, 11
    s_mul_i32 s36, s36, 39680
    s_lshl_b32 s37, s37, 7
    s_add_u32 s36, s36, s37
    s_mul_i32 s37, s32, 10240
    s_add_u32 m0, s56, 20480
    s_add_u32 s36, s36, s37
    buffer_load_dwordx4 v245, s[16:19], s36 offen lds
    s_lshl2_add_u32 s37, s59, 2
    s_mul_i32 s36, s37, 205
    s_lshr_b32 s36, s36, 11
    s_mul_i32 s36, s36, 39680
    s_lshl_b32 s37, s37, 7
    s_add_u32 s36, s36, s37
    s_mul_i32 s37, s32, 10240
    s_add_u32 m0, s56, 24576
    s_add_u32 s36, s36, s37
    buffer_load_dwordx4 v245, s[16:19], s36 offen lds
    s_lshl2_add_u32 s37, s59, 3
    s_mul_i32 s36, s37, 205
    s_lshr_b32 s36, s36, 11
    s_mul_i32 s36, s36, 39680
    s_lshl_b32 s37, s37, 7
    s_add_u32 s36, s36, s37
    s_mul_i32 s37, s32, 10240
    s_add_u32 m0, s56, 28672
    s_add_u32 s36, s36, s37
    buffer_load_dwordx4 v245, s[16:19], s36 offen lds
    s_branch L_helper
L_worker:
    s_lshl_b32 s62, s32, 12
    s_add_u32 m0, s40, 0
    s_nop 0
    buffer_load_dwordx4 v4, s[4:7], s52 offen lds
    buffer_load_dwordx4 v5, s[4:7], s52 offen offset:1024 lds
    s_add_u32 m0, s62, 0
    s_mul_i32 s53, s52, 1536
    s_mul_i32 s70, s95, 3
    s_add_u32 s70, s70, s99
    s_mul_i32 s36, s32, 49152
    s_lshl_b32 s37, s70, 8
    s_add_u32 s36, s36, s37
    s_add_u32 s36, s36, 1536
    v_and_b32 v1, 15, v0
    v_lshlrev_b32 v2, 1, v240
    v_xor_b32 v1, v1, v2
    v_lshlrev_b32 v1, 4, v1
    v_mul_u32_u24 v2, 3072, v240
    v_add3_u32 v8, v2, v1, s36
    v_add_u32 v9, 11264, v8
    v_xor_b32 v1, 128, v1
    s_add_u32 s36, s36, 22528
    v_add3_u32 v10, v2, v1, s36
    v_add_u32 v11, 11264, v10
    buffer_load_dwordx4 v8, s[8:11], s53 offen lds
    buffer_load_dwordx4 v9, s[8:11], s53 offen offset:1024 lds
    buffer_load_dwordx4 v10, s[8:11], s53 offen offset:2048 lds
    buffer_load_dwordx4 v11, s[8:11], s53 offen offset:3072 lds
    s_add_u32 s52, s52, 128
    s_cmp_eq_u32 s52, 1280
    s_cselect_b32 s52, 0, s52
    s_mov_b32 s36, s52
    s_add_u32 s52, s52, 128
    s_cmp_eq_u32 s52, 1280
    s_cselect_b32 s52, 0, s52
    s_bitcmp1_b32 s99, 1
    s_cselect_b32 s54, s52, s36
    s_cselect_b32 s96, s36, s52
    s_cselect_b32 s55, 2048, 0
    s_sub_u32 s97, 4096, s55
    s_add_u32 s55, s55, 2048
    s_add_u32 m0, s40, s55
    s_nop 0
    buffer_load_dwordx4 v4, s[4:7], s54 offen lds
    buffer_load_dwordx4 v5, s[4:7], s54 offen offset:1024 lds
    s_add_u32 m0, s40, s97
    v_and_b32 v241, 15, v0
    v_lshrrev_b32 v2, 1, v241
    v_xor_b32 v2, v2, v240
    v_lshlrev_b32 v2, 4, v2
    v_lshl_add_u32 v2, v241, 7, v2
    v_add_u32 v6, s40, v2
    v_xor_b32 v7, 64, v6
    v_bfe_u32 v243, v0, 2, 2
    v_and_b32 v244, 3, v0
    v_and_b32 v242, 1, v240
    v_lshl_add_u32 v1, v240, 3, v243
    v_lshlrev_b32 v1, 8, v1
    v_lshl_add_u32 v1, v244, 3, v1
    v_lshl_add_u32 v2, v242, 2, v243
    v_lshl_add_u32 v144, v2, 5, v1
    v_xor_b32 v145, 32, v144
    v_xor_b32 v146, 64, v144
    v_xor_b32 v147, 96, v144
    v_xor_b32 v148, 128, v144
    v_xor_b32 v149, 160, v144
    v_xor_b32 v150, 192, v144
    v_xor_b32 v151, 224, v144
    buffer_load_dwordx4 v4, s[4:7], s96 offen lds
    buffer_load_dwordx4 v5, s[4:7], s96 offen offset:1024 lds
    s_add_u32 m0, s62, 16384
    s_add_u32 s53, s53, 196608
    s_cmp_eq_u32 s53, 1966080
    s_cselect_b32 s53, 0, s53
    s_mov_b32 s18, 983040
    s_mov_b32 s19, 0x20000
    s_mov_b32 s14, 8388608
    s_mov_b32 s15, 0x20000
    s_mov_b32 s22, 2621440
    s_mov_b32 s23, 0x20000
    s_mov_b32 s26, 10485760
    s_mov_b32 s27, 0x20000
    s_mov_b32 s30, 4096
    s_mov_b32 s31, 0x20000
    s_lshl3_add_u32 s54, s101, s34
    s_mul_i32 s54, s54, 3072
    s_add_u32 s98, s54, 4194304
    v_mov_b32 v152, -1
    v_mov_b32 v153, -1
    v_mov_b32 v154, -1
    v_mov_b32 v155, -1
    s_lshl_b32 s54, s33, 18
    s_lshl_b32 s55, s32, 10
    s_add_u32 s54, s54, s55
    v_lshlrev_b32 v2, 12, v3
    v_add3_u32 v13, v2, v13, s54
    s_add_u32 s54, s54, 31744
    v_add3_u32 v14, v2, v14, s54
    s_mul_i32 s54, s92, 1
    s_lshl2_add_u32 s54, s95, s54
    s_add_u32 s55, s54, 0
    s_and_b32 s55, s55, 7
    s_lshl_b32 s72, s55, 11
    s_lshl_b32 s80, s55, 7
    s_mov_b64 exec, 0
    s_cmp_eq_u32 s32, 0
    s_cbranch_scc1 L_page1
    s_cmp_eq_u32 s32, 1
    s_cbranch_scc1 L_page2
    s_cmp_eq_u32 s32, 2
    s_cbranch_scc1 L_page3
    s_cmp_eq_u32 s32, 3
    s_cbranch_scc1 L_page4
L_ret0:
    s_cmp_eq_u32 s71, 1
    s_cbranch_scc1 L_hret0
    s_mov_b64 exec, -1
    buffer_load_dwordx4 v8, s[8:11], s53 offen lds
    buffer_load_dwordx4 v9, s[8:11], s53 offen offset:1024 lds
    buffer_load_dwordx4 v10, s[8:11], s53 offen offset:2048 lds
    buffer_load_dwordx4 v11, s[8:11], s53 offen offset:3072 lds
    s_add_u32 m0, s62, 32768
    s_mul_i32 s53, s52, 1536
    s_waitcnt vmcnt(8)
    s_barrier
    buffer_load_dwordx4 v8, s[8:11], s53 offen lds
    s_add_u32 s55, s54, 1
    ds_read_b128 v[32:35], v6 offset:0
    s_and_b32 s55, s55, 7
    ds_read_b64_tr_b16 v[168:169], v144 offset:0
    s_lshl_b32 s73, s55, 11
    ds_read_b64_tr_b16 v[170:171], v144 offset:1024
    s_lshl_b32 s81, s55, 7
    ds_read_b64_tr_b16 v[172:173], v145 offset:0
    s_add_u32 s55, s54, 2
    ds_read_b64_tr_b16 v[174:175], v145 offset:1024
    s_and_b32 s55, s55, 7
    ds_read_b64_tr_b16 v[176:177], v146 offset:0
    s_lshl_b32 s74, s55, 11
    ds_read_b64_tr_b16 v[178:179], v146 offset:1024
    buffer_load_dwordx4 v9, s[8:11], s53 offen offset:1024 lds
    s_lshl_b32 s82, s55, 7
    ds_read_b64_tr_b16 v[180:181], v147 offset:0
    s_add_u32 s55, s54, 3
    s_and_b32 s55, s55, 7
    ds_read_b64_tr_b16 v[182:183], v147 offset:1024
    s_lshl_b32 s75, s55, 11
    ds_read_b64_tr_b16 v[184:185], v148 offset:0
    s_lshl_b32 s83, s55, 7
    ds_read_b64_tr_b16 v[186:187], v148 offset:1024
    s_add_u32 s55, s54, 4
    ds_read_b64_tr_b16 v[188:189], v149 offset:0
    s_and_b32 s55, s55, 7
    ds_read_b64_tr_b16 v[190:191], v149 offset:1024
    buffer_load_dwordx4 v10, s[8:11], s53 offen offset:2048 lds
    s_lshl_b32 s76, s55, 11
    ds_read_b64_tr_b16 v[192:193], v150 offset:0
    s_lshl_b32 s84, s55, 7
    ds_read_b64_tr_b16 v[194:195], v150 offset:1024
    s_add_u32 s55, s54, 5
    ds_read_b64_tr_b16 v[196:197], v151 offset:0
    s_and_b32 s55, s55, 7
    s_lshl_b32 s77, s55, 11
    ds_read_b64_tr_b16 v[198:199], v151 offset:1024
    s_lshl_b32 s85, s55, 7
    ds_read_b128 v[36:39], v7 offset:0
    s_add_u32 s55, s54, 6
    ds_read_b64_tr_b16 v[200:201], v144 offset:8192
    s_and_b32 s55, s55, 7
    ds_read_b64_tr_b16 v[202:203], v144 offset:9216
    buffer_load_dwordx4 v11, s[8:11], s53 offen offset:3072 lds
    s_add_u32 m0, s40, 6144
    s_add_u32 s52, s52, 128
    s_cmp_eq_u32 s52, 1280
    s_cselect_b32 s52, 0, s52
    s_lshl_b32 s78, s55, 11
    s_waitcnt lgkmcnt(11)
    v_mfma_f32_16x16x32_bf16 v[112:115], v[32:35], v[168:171], 0
    s_lshl_b32 s86, s55, 7
    ds_read_b64_tr_b16 v[204:205], v145 offset:8192
    s_add_u32 s55, s54, 7
    ds_read_b64_tr_b16 v[206:207], v145 offset:9216
    s_and_b32 s55, s55, 7
    v_mfma_f32_16x16x32_bf16 v[116:119], v[32:35], v[172:175], 0
    s_lshl_b32 s79, s55, 11
    ds_read_b64_tr_b16 v[208:209], v146 offset:8192
    s_lshl_b32 s87, s55, 7
    ds_read_b64_tr_b16 v[210:211], v146 offset:9216
    s_add_u32 s55, s32, 0
    v_mfma_f32_16x16x32_bf16 v[120:123], v[32:35], v[176:179], 0
    buffer_load_dwordx4 v4, s[4:7], s52 offen lds
    s_and_b32 s55, s55, 3
    ds_read_b64_tr_b16 v[212:213], v147 offset:8192
    s_lshl_b32 s88, s55, 16
    ds_read_b64_tr_b16 v[214:215], v147 offset:9216
    s_mul_i32 s55, s55, 3072
    v_mfma_f32_16x16x32_bf16 v[124:127], v[32:35], v[180:183], 0
    s_add_u32 s55, s55, 122880
    ds_read_b64_tr_b16 v[216:217], v148 offset:8192
    v_add_u32 v26, s55, v21
    ds_read_b64_tr_b16 v[218:219], v148 offset:9216
    s_add_u32 s55, s32, 1
    s_waitcnt lgkmcnt(11)
    v_mfma_f32_16x16x32_bf16 v[128:131], v[32:35], v[184:187], 0
    s_and_b32 s55, s55, 3
    ds_read_b64_tr_b16 v[220:221], v149 offset:8192
    buffer_load_dwordx4 v5, s[4:7], s52 offen offset:1024 lds
    s_add_u32 m0, s62, 49152
    s_mul_i32 s53, s52, 1536
    s_lshl_b32 s89, s55, 16
    ds_read_b64_tr_b16 v[222:223], v149 offset:9216
    s_mul_i32 s55, s55, 3072
    v_mfma_f32_16x16x32_bf16 v[132:135], v[32:35], v[188:191], 0
    s_add_u32 s55, s55, 122880
    ds_read_b64_tr_b16 v[224:225], v150 offset:8192
    v_add_u32 v23, s55, v21
    ds_read_b64_tr_b16 v[226:227], v150 offset:9216
    s_add_u32 s55, s32, 2
    v_mfma_f32_16x16x32_bf16 v[136:139], v[32:35], v[192:195], 0
    s_and_b32 s55, s55, 3
    ds_read_b64_tr_b16 v[228:229], v151 offset:8192
    s_lshl_b32 s90, s55, 16
    ds_read_b64_tr_b16 v[230:231], v151 offset:9216
    s_mul_i32 s55, s55, 3072
    v_mfma_f32_16x16x32_bf16 v[140:143], v[32:35], v[196:199], 0
    s_mov_b64 exec, 0
    s_cmp_eq_u32 s32, 0
    s_cbranch_scc1 L_page5
    s_cmp_eq_u32 s32, 1
    s_cbranch_scc1 L_page6
    s_cmp_eq_u32 s32, 2
    s_cbranch_scc1 L_page7
    s_cmp_eq_u32 s32, 3
    s_cbranch_scc1 L_ret1
L_ret1:
    s_cmp_eq_u32 s71, 1
    s_cbranch_scc1 L_hret1
    s_mov_b64 exec, -1
    s_waitcnt vmcnt(6)
    s_barrier
    buffer_load_dwordx4 v8, s[8:11], s53 offen lds
    s_add_u32 s55, s55, 123904
    ds_read_b128 v[40:43], v6 offset:2048
    v_add_u32 v24, s55, v21
    ds_read_b64_tr_b16 v[168:169], v144 offset:16384
    s_add_u32 s55, s32, 3
    ds_read_b64_tr_b16 v[170:171], v144 offset:17408
    s_and_b32 s55, s55, 3
    s_waitcnt lgkmcnt(11)
    v_mfma_f32_16x16x32_bf16 v[112:115], v[36:39], v[200:203], v[112:115]
    s_lshl_b32 s91, s55, 16
    ds_read_b64_tr_b16 v[172:173], v145 offset:16384
    s_mul_i32 s55, s55, 3072
    ds_read_b64_tr_b16 v[174:175], v145 offset:17408
    v_mfma_f32_16x16x32_bf16 v[116:119], v[36:39], v[204:207], v[116:119]
    s_add_u32 s55, s55, 124928
    ds_read_b64_tr_b16 v[176:177], v146 offset:16384
    buffer_load_dwordx4 v9, s[8:11], s53 offen offset:1024 lds
    v_add_u32 v25, s55, v21
    ds_read_b64_tr_b16 v[178:179], v146 offset:17408
    v_lshlrev_b32 v19, 16, v242
    v_mfma_f32_16x16x32_bf16 v[120:123], v[36:39], v[208:211], v[120:123]
    v_lshl_add_u32 v19, v241, 4, v19
    ds_read_b64_tr_b16 v[180:181], v147 offset:16384
    v_lshrrev_b32 v1, 5, v0
    ds_read_b64_tr_b16 v[182:183], v147 offset:17408
    v_mfma_f32_16x16x32_bf16 v[124:127], v[36:39], v[212:215], v[124:127]
    v_lshl_add_u32 v19, v1, 8, v19
    ds_read_b64_tr_b16 v[184:185], v148 offset:16384
    s_lshl_b32 s54, s70, 19
    ds_read_b64_tr_b16 v[186:187], v148 offset:17408
    s_lshl_b32 s55, s101, 9
    s_waitcnt lgkmcnt(11)
    v_mfma_f32_16x16x32_bf16 v[128:131], v[36:39], v[216:219], v[128:131]
    buffer_load_dwordx4 v10, s[8:11], s53 offen offset:2048 lds
    s_add_u32 s54, s54, s55
    ds_read_b64_tr_b16 v[188:189], v149 offset:16384
    s_add_u32 s54, s54, 1048576
    ds_read_b64_tr_b16 v[190:191], v149 offset:17408
    v_add_u32 v19, s54, v19
    v_mfma_f32_16x16x32_bf16 v[132:135], v[36:39], v[220:223], v[132:135]
    s_lshl_b32 s54, s70, 5
    ds_read_b64_tr_b16 v[192:193], v150 offset:16384
    s_add_u32 s54, s54, s33
    ds_read_b64_tr_b16 v[194:195], v150 offset:17408
    v_mfma_f32_16x16x32_bf16 v[136:139], v[36:39], v[224:227], v[136:139]
    s_lshl_b32 s54, s54, 7
    ds_read_b64_tr_b16 v[196:197], v151 offset:16384
    s_add_u32 s96, s54, 4096
    ds_read_b64_tr_b16 v[198:199], v151 offset:17408
    s_mov_b32 s42, 0xaaaaaaaa
    v_mfma_f32_16x16x32_bf16 v[140:143], v[36:39], v[228:231], v[140:143]
    buffer_load_dwordx4 v11, s[8:11], s53 offen offset:3072 lds
    s_add_u32 m0, s40, 8192
    s_add_u32 s52, s52, 128
    s_cmp_eq_u32 s52, 1280
    s_cselect_b32 s52, 0, s52
    s_mov_b32 s43, 0xaaaaaaaa
    ds_read_b128 v[44:47], v7 offset:2048
    s_mov_b32 s44, 0xcccccccc
    ds_read_b64_tr_b16 v[200:201], v144 offset:24576
    s_mov_b32 s45, 0xcccccccc
    ds_read_b64_tr_b16 v[202:203], v144 offset:25600
    s_lshl1_add_u32 s54, s101, s95
    s_waitcnt lgkmcnt(11)
    v_mfma_f32_16x16x32_bf16 v[112:115], v[40:43], v[168:171], v[112:115]
    s_and_b32 s55, s92, 3
    ds_read_b64_tr_b16 v[204:205], v145 offset:24576
    s_lshl2_add_u32 s54, s54, s55
    ds_read_b64_tr_b16 v[206:207], v145 offset:25600
    v_mfma_f32_16x16x32_bf16 v[116:119], v[40:43], v[172:175], v[116:119]
    s_mul_i32 s54, s54, 3
    ds_read_b64_tr_b16 v[208:209], v146 offset:24576
    buffer_load_dwordx4 v4, s[4:7], s52 offen lds
    s_add_u32 s54, s54, s99
    ds_read_b64_tr_b16 v[210:211], v146 offset:25600
    s_lshl_b32 s54, s54, 10
    v_mfma_f32_16x16x32_bf16 v[120:123], v[40:43], v[176:179], v[120:123]
    s_add_u32 s100, s54, 4194304
    ds_read_b64_tr_b16 v[212:213], v147 offset:24576
    s_lshl_b32 s54, s101, 5
    ds_read_b64_tr_b16 v[214:215], v147 offset:25600
    v_mfma_f32_16x16x32_bf16 v[124:127], v[40:43], v[180:183], v[124:127]
    v_lshlrev_b32 v2, 1, v241
    ds_read_b64_tr_b16 v[216:217], v148 offset:24576
    buffer_load_ushort v16, v2, s[28:31], s54 offen
    ds_read_b64_tr_b16 v[218:219], v148 offset:25600
    s_mul_i32 s41, s32, 3072
    s_waitcnt lgkmcnt(11)
    v_mfma_f32_16x16x32_bf16 v[128:131], v[40:43], v[184:187], v[128:131]
    buffer_load_dwordx4 v5, s[4:7], s52 offen offset:1024 lds
    s_add_u32 m0, s62, 0
    s_mul_i32 s53, s52, 1536
    s_lshr_b32 s54, s32, 1
    ds_read_b64_tr_b16 v[220:221], v149 offset:24576
    s_mul_i32 s55, s54, 43008
    ds_read_b64_tr_b16 v[222:223], v149 offset:25600
    s_add_u32 s55, s55, s41
    v_mfma_f32_16x16x32_bf16 v[132:135], v[40:43], v[188:191], v[132:135]
    s_mul_i32 s56, s34, 6144
    ds_read_b64_tr_b16 v[224:225], v150 offset:24576
    s_add_u32 s55, s55, s56
    ds_read_b64_tr_b16 v[226:227], v150 offset:25600
    v_mfma_f32_16x16x32_bf16 v[136:139], v[40:43], v[192:195], v[136:139]
    s_add_u32 s55, s55, 9437184
    ds_read_b64_tr_b16 v[228:229], v151 offset:24576
    v_add_u32 v12, s55, v21
    ds_read_b64_tr_b16 v[230:231], v151 offset:25600
    s_mul_i32 s55, s34, 3
    v_mfma_f32_16x16x32_bf16 v[140:143], v[40:43], v[196:199], v[140:143]
    s_waitcnt vmcnt(9)
    s_barrier
    buffer_load_dwordx4 v8, s[8:11], s53 offen lds
    ds_read_b128 v[48:51], v6 offset:4096
    s_lshr_b32 s56, s55, 1
    ds_read_b64_tr_b16 v[168:169], v144 offset:32768
    s_add_u32 s56, s56, s54
    ds_read_b64_tr_b16 v[170:171], v144 offset:33792
    s_lshr_b32 s56, s56, 2
    s_waitcnt lgkmcnt(11)
    v_mfma_f32_16x16x32_bf16 v[112:115], v[44:47], v[200:203], v[112:115]
    s_and_b32 s54, s32, 1
    ds_read_b64_tr_b16 v[172:173], v145 offset:32768
    s_lshl1_add_u32 s56, s56, s54
    ds_read_b64_tr_b16 v[174:175], v145 offset:33792
    s_mul_i32 s56, s56, 1280
    v_mfma_f32_16x16x32_bf16 v[116:119], v[44:47], v[204:207], v[116:119]
    s_add_u32 s58, s56, 65536
    ds_read_b64_tr_b16 v[176:177], v146 offset:32768
    buffer_load_dwordx4 v9, s[8:11], s53 offen offset:1024 lds
    v_lshrrev_b32 v1, 2, v0
    ds_read_b64_tr_b16 v[178:179], v146 offset:33792
    v_mfma_f32_16x16x32_bf16 v[120:123], v[44:47], v[208:211], v[120:123]
    v_min_u32 v255, 9, v1
    ds_read_b64_tr_b16 v[180:181], v147 offset:32768
    v_lshlrev_b32 v255, 7, v255
    ds_read_b64_tr_b16 v[182:183], v147 offset:33792
    v_lshl_add_u32 v255, v244, 2, v255
    v_mfma_f32_16x16x32_bf16 v[124:127], v[44:47], v[212:215], v[124:127]
    ds_read_b64_tr_b16 v[184:185], v148 offset:32768
    s_lshr_b32 s54, s55, 2
    ds_read_b64_tr_b16 v[186:187], v148 offset:33792
    s_lshl1_add_u32 s55, s55, 5
    s_waitcnt lgkmcnt(11)
    v_mfma_f32_16x16x32_bf16 v[128:131], v[44:47], v[216:219], v[128:131]
    buffer_load_dwordx4 v10, s[8:11], s53 offen offset:2048 lds
    s_lshr_b32 s55, s55, 3
    ds_read_b64_tr_b16 v[188:189], v149 offset:32768
    s_sub_u32 s55, s55, s54
    ds_read_b64_tr_b16 v[190:191], v149 offset:33792
    s_lshl_b32 s55, s55, 12
    v_mfma_f32_16x16x32_bf16 v[132:135], v[44:47], v[220:223], v[132:135]
    v_and_b32 v1, 7, v1
    ds_read_b64_tr_b16 v[192:193], v150 offset:32768
    v_lshlrev_b32 v22, 2, v244
    ds_read_b64_tr_b16 v[194:195], v150 offset:33792
    v_mfma_f32_16x16x32_bf16 v[136:139], v[44:47], v[224:227], v[136:139]
    v_lshl_add_u32 v22, v1, 7, v22
    ds_read_b64_tr_b16 v[196:197], v151 offset:32768
    v_lshrrev_b32 v1, 5, v0
    ds_read_b64_tr_b16 v[198:199], v151 offset:33792
    v_mad_u32_u24 v22, v1, s55, v22
    v_mfma_f32_16x16x32_bf16 v[140:143], v[44:47], v[228:231], v[140:143]
    buffer_load_dwordx4 v11, s[8:11], s53 offen offset:3072 lds
L_page1:
    s_cbranch_execz L_ret0
    s_add_u32 m0, s40, 10240
    s_add_u32 s52, s52, 128
    s_cmp_eq_u32 s52, 1280
    s_cselect_b32 s52, 0, s52
    ds_read_b128 v[52:55], v7 offset:4096
    s_lshl2_add_u32 s54, s54, s32
    ds_read_b64_tr_b16 v[200:201], v144 offset:40960
    s_lshl_b32 s54, s54, 10
    ds_read_b64_tr_b16 v[202:203], v144 offset:41984
    s_add_u32 s97, s54, 4096
    s_waitcnt lgkmcnt(11)
    v_mfma_f32_16x16x32_bf16 v[112:115], v[48:51], v[168:171], v[112:115]
    s_mul_i32 s54, s34, 393216
    ds_read_b64_tr_b16 v[204:205], v145 offset:40960
    s_lshl_b32 s55, s32, 14
    ds_read_b64_tr_b16 v[206:207], v145 offset:41984
    s_add_u32 s55, s55, s54
    v_mfma_f32_16x16x32_bf16 v[116:119], v[48:51], v[172:175], v[116:119]
    s_add_u32 s55, s55, 1048576
    ds_read_b64_tr_b16 v[208:209], v146 offset:40960
    buffer_load_dwordx4 v4, s[4:7], s52 offen lds
    v_add_u32 v20, s55, v21
    ds_read_b64_tr_b16 v[210:211], v146 offset:41984
    v_mfma_f32_16x16x32_bf16 v[120:123], v[48:51], v[176:179], v[120:123]
    v_lshl_add_u32 v15, v240, 2, v244
    ds_read_b64_tr_b16 v[212:213], v147 offset:40960
    v_lshlrev_b32 v15, 4, v15
    ds_read_b64_tr_b16 v[214:215], v147 offset:41984
    s_lshl_b32 s54, s101, 11
    v_mfma_f32_16x16x32_bf16 v[124:127], v[48:51], v[180:183], v[124:127]
    ds_read_b64_tr_b16 v[216:217], v148 offset:40960
    s_add_u32 s54, s54, 262144
    ds_read_b64_tr_b16 v[218:219], v148 offset:41984
    v_lshl_add_u32 v18, v243, 8, v15
    s_waitcnt lgkmcnt(11)
    v_mfma_f32_16x16x32_bf16 v[128:131], v[48:51], v[184:187], v[128:131]
    buffer_load_dwordx4 v5, s[4:7], s52 offen offset:1024 lds
    s_add_u32 m0, s62, 16384
    s_mul_i32 s53, s52, 1536
    v_add_u32 v18, s54, v18
    ds_read_b64_tr_b16 v[220:221], v149 offset:40960
    s_lshl_b32 s55, s34, 8
    ds_read_b64_tr_b16 v[222:223], v149 offset:41984
    s_add_u32 s54, s54, s55
    v_mfma_f32_16x16x32_bf16 v[132:135], v[48:51], v[188:191], v[132:135]
    v_add_u32 v15, s54, v15
    ds_read_b64_tr_b16 v[224:225], v150 offset:40960
    s_mov_b32 s46, 0xbdd2d3e8
    ds_read_b64_tr_b16 v[226:227], v150 offset:41984
    v_mfma_f32_16x16x32_bf16 v[136:139], v[48:51], v[192:195], v[136:139]
    s_mov_b32 s47, 0xbdd2d3e8
    ds_read_b64_tr_b16 v[228:229], v151 offset:40960
    v_mov_b32 v2, 0xc0135761
    ds_read_b64_tr_b16 v[230:231], v151 offset:41984
    v_mov_b32 v3, 0xc0135761
    v_mfma_f32_16x16x32_bf16 v[140:143], v[48:51], v[196:199], v[140:143]
    s_waitcnt vmcnt(9)
    s_barrier
    buffer_load_dwordx4 v8, s[8:11], s53 offen lds
    ds_read_b128 v[56:59], v6 offset:6144
    ds_read_b64_tr_b16 v[168:169], v144 offset:49152
    ds_read_b64_tr_b16 v[170:171], v144 offset:50176
    s_waitcnt lgkmcnt(11)
    v_mfma_f32_16x16x32_bf16 v[112:115], v[52:55], v[200:203], v[112:115]
    ds_read_b64_tr_b16 v[172:173], v145 offset:49152
    ds_read_b64_tr_b16 v[174:175], v145 offset:50176
    v_mfma_f32_16x16x32_bf16 v[116:119], v[52:55], v[204:207], v[116:119]
    ds_read_b64_tr_b16 v[176:177], v146 offset:49152
    buffer_load_dwordx4 v9, s[8:11], s53 offen offset:1024 lds
    ds_read_b64_tr_b16 v[178:179], v146 offset:50176
    v_mfma_f32_16x16x32_bf16 v[120:123], v[52:55], v[208:211], v[120:123]
    ds_read_b64_tr_b16 v[180:181], v147 offset:49152
    ds_read_b64_tr_b16 v[182:183], v147 offset:50176
    v_mfma_f32_16x16x32_bf16 v[124:127], v[52:55], v[212:215], v[124:127]
    ds_read_b64_tr_b16 v[184:185], v148 offset:49152
    ds_read_b64_tr_b16 v[186:187], v148 offset:50176
    s_waitcnt lgkmcnt(11)
    v_mfma_f32_16x16x32_bf16 v[128:131], v[52:55], v[216:219], v[128:131]
    buffer_load_dwordx4 v10, s[8:11], s53 offen offset:2048 lds
    ds_read_b64_tr_b16 v[188:189], v149 offset:49152
    ds_read_b64_tr_b16 v[190:191], v149 offset:50176
    v_mfma_f32_16x16x32_bf16 v[132:135], v[52:55], v[220:223], v[132:135]
    ds_read_b64_tr_b16 v[192:193], v150 offset:49152
    ds_read_b64_tr_b16 v[194:195], v150 offset:50176
    v_mfma_f32_16x16x32_bf16 v[136:139], v[52:55], v[224:227], v[136:139]
    ds_read_b64_tr_b16 v[196:197], v151 offset:49152
    ds_read_b64_tr_b16 v[198:199], v151 offset:50176
    v_mfma_f32_16x16x32_bf16 v[140:143], v[52:55], v[228:231], v[140:143]
    buffer_load_dwordx4 v11, s[8:11], s53 offen offset:3072 lds
    s_add_u32 m0, s40, 12288
    s_add_u32 s52, s52, 128
    s_cmp_eq_u32 s52, 1280
    s_cselect_b32 s52, 0, s52
    ds_read_b128 v[60:63], v7 offset:6144
    ds_read_b64_tr_b16 v[200:201], v144 offset:57344
    ds_read_b64_tr_b16 v[202:203], v144 offset:58368
    s_waitcnt lgkmcnt(11)
    v_mfma_f32_16x16x32_bf16 v[112:115], v[56:59], v[168:171], v[112:115]
    buffer_store_dwordx4 v[152:155], v21, s[24:27], s98 offen offset:0 sc1
    ds_read_b64_tr_b16 v[204:205], v145 offset:57344
    ds_read_b64_tr_b16 v[206:207], v145 offset:58368
    v_mfma_f32_16x16x32_bf16 v[116:119], v[56:59], v[172:175], v[116:119]
    ds_read_b64_tr_b16 v[208:209], v146 offset:57344
    buffer_load_dwordx4 v4, s[4:7], s52 offen lds
    ds_read_b64_tr_b16 v[210:211], v146 offset:58368
    v_mfma_f32_16x16x32_bf16 v[120:123], v[56:59], v[176:179], v[120:123]
    ds_read_b64_tr_b16 v[212:213], v147 offset:57344
    ds_read_b64_tr_b16 v[214:215], v147 offset:58368
    v_mfma_f32_16x16x32_bf16 v[124:127], v[56:59], v[180:183], v[124:127]
    ds_read_b64_tr_b16 v[216:217], v148 offset:57344
    ds_read_b64_tr_b16 v[218:219], v148 offset:58368
    s_waitcnt lgkmcnt(11)
    v_mfma_f32_16x16x32_bf16 v[128:131], v[56:59], v[184:187], v[128:131]
    buffer_load_dwordx4 v5, s[4:7], s52 offen offset:1024 lds
    s_add_u32 m0, s62, 32768
    s_mul_i32 s53, s52, 1536
    ds_read_b64_tr_b16 v[220:221], v149 offset:57344
    ds_read_b64_tr_b16 v[222:223], v149 offset:58368
    v_mfma_f32_16x16x32_bf16 v[132:135], v[56:59], v[188:191], v[132:135]
    ds_read_b64_tr_b16 v[224:225], v150 offset:57344
    ds_read_b64_tr_b16 v[226:227], v150 offset:58368
    v_mfma_f32_16x16x32_bf16 v[136:139], v[56:59], v[192:195], v[136:139]
    ds_read_b64_tr_b16 v[228:229], v151 offset:57344
    ds_read_b64_tr_b16 v[230:231], v151 offset:58368
    v_mfma_f32_16x16x32_bf16 v[140:143], v[56:59], v[196:199], v[140:143]
    s_waitcnt vmcnt(9)
    s_barrier
    buffer_load_dwordx4 v8, s[8:11], s53 offen lds
    ds_read_b128 v[64:67], v6 offset:8192
    ds_read_b64_tr_b16 v[168:169], v144 offset:0
    ds_read_b64_tr_b16 v[170:171], v144 offset:1024
    s_waitcnt lgkmcnt(11)
    v_mfma_f32_16x16x32_bf16 v[112:115], v[60:63], v[200:203], v[112:115]
    ds_read_b64_tr_b16 v[172:173], v145 offset:0
    ds_read_b64_tr_b16 v[174:175], v145 offset:1024
    v_mfma_f32_16x16x32_bf16 v[116:119], v[60:63], v[204:207], v[116:119]
    ds_read_b64_tr_b16 v[176:177], v146 offset:0
    buffer_load_dwordx4 v9, s[8:11], s53 offen offset:1024 lds
    ds_read_b64_tr_b16 v[178:179], v146 offset:1024
    v_mfma_f32_16x16x32_bf16 v[120:123], v[60:63], v[208:211], v[120:123]
    ds_read_b64_tr_b16 v[180:181], v147 offset:0
    ds_read_b64_tr_b16 v[182:183], v147 offset:1024
    v_mfma_f32_16x16x32_bf16 v[124:127], v[60:63], v[212:215], v[124:127]
    ds_read_b64_tr_b16 v[184:185], v148 offset:0
    ds_read_b64_tr_b16 v[186:187], v148 offset:1024
    s_waitcnt lgkmcnt(11)
    v_mfma_f32_16x16x32_bf16 v[128:131], v[60:63], v[216:219], v[128:131]
    buffer_load_dwordx4 v10, s[8:11], s53 offen offset:2048 lds
    ds_read_b64_tr_b16 v[188:189], v149 offset:0
    ds_read_b64_tr_b16 v[190:191], v149 offset:1024
    v_mfma_f32_16x16x32_bf16 v[132:135], v[60:63], v[220:223], v[132:135]
    ds_read_b64_tr_b16 v[192:193], v150 offset:0
    ds_read_b64_tr_b16 v[194:195], v150 offset:1024
    v_mfma_f32_16x16x32_bf16 v[136:139], v[60:63], v[224:227], v[136:139]
    ds_read_b64_tr_b16 v[196:197], v151 offset:0
    ds_read_b64_tr_b16 v[198:199], v151 offset:1024
    v_mfma_f32_16x16x32_bf16 v[140:143], v[60:63], v[228:231], v[140:143]
    buffer_load_dwordx4 v11, s[8:11], s53 offen offset:3072 lds
    s_add_u32 m0, s40, 14336
    s_add_u32 s52, s52, 128
    s_cmp_eq_u32 s52, 1280
    s_cselect_b32 s52, 0, s52
    ds_read_b128 v[68:71], v7 offset:8192
    ds_read_b64_tr_b16 v[200:201], v144 offset:8192
    ds_read_b64_tr_b16 v[202:203], v144 offset:9216
    s_waitcnt lgkmcnt(11)
    v_mfma_f32_16x16x32_bf16 v[112:115], v[64:67], v[168:171], v[112:115]
    ds_read_b64_tr_b16 v[204:205], v145 offset:8192
    ds_read_b64_tr_b16 v[206:207], v145 offset:9216
    v_mfma_f32_16x16x32_bf16 v[116:119], v[64:67], v[172:175], v[116:119]
    ds_read_b64_tr_b16 v[208:209], v146 offset:8192
    buffer_load_dwordx4 v4, s[4:7], s52 offen lds
    ds_read_b64_tr_b16 v[210:211], v146 offset:9216
    v_mfma_f32_16x16x32_bf16 v[120:123], v[64:67], v[176:179], v[120:123]
    ds_read_b64_tr_b16 v[212:213], v147 offset:8192
    ds_read_b64_tr_b16 v[214:215], v147 offset:9216
    v_mfma_f32_16x16x32_bf16 v[124:127], v[64:67], v[180:183], v[124:127]
    ds_read_b64_tr_b16 v[216:217], v148 offset:8192
    ds_read_b64_tr_b16 v[218:219], v148 offset:9216
    s_waitcnt lgkmcnt(11)
    v_mfma_f32_16x16x32_bf16 v[128:131], v[64:67], v[184:187], v[128:131]
    buffer_load_dwordx4 v5, s[4:7], s52 offen offset:1024 lds
    s_add_u32 m0, s62, 49152
    s_mul_i32 s53, s52, 1536
    ds_read_b64_tr_b16 v[220:221], v149 offset:8192
    ds_read_b64_tr_b16 v[222:223], v149 offset:9216
    v_mfma_f32_16x16x32_bf16 v[132:135], v[64:67], v[188:191], v[132:135]
    ds_read_b64_tr_b16 v[224:225], v150 offset:8192
    ds_read_b64_tr_b16 v[226:227], v150 offset:9216
    v_mfma_f32_16x16x32_bf16 v[136:139], v[64:67], v[192:195], v[136:139]
    ds_read_b64_tr_b16 v[228:229], v151 offset:8192
    ds_read_b64_tr_b16 v[230:231], v151 offset:9216
    v_mfma_f32_16x16x32_bf16 v[140:143], v[64:67], v[196:199], v[140:143]
    s_waitcnt vmcnt(9)
    s_barrier
    buffer_load_dwordx4 v8, s[8:11], s53 offen lds
    ds_read_b128 v[72:75], v6 offset:10240
    ds_read_b64_tr_b16 v[168:169], v144 offset:16384
    ds_read_b64_tr_b16 v[170:171], v144 offset:17408
    s_waitcnt lgkmcnt(11)
    v_mfma_f32_16x16x32_bf16 v[112:115], v[68:71], v[200:203], v[112:115]
    ds_read_b64_tr_b16 v[172:173], v145 offset:16384
    ds_read_b64_tr_b16 v[174:175], v145 offset:17408
    v_mfma_f32_16x16x32_bf16 v[116:119], v[68:71], v[204:207], v[116:119]
    ds_read_b64_tr_b16 v[176:177], v146 offset:16384
    buffer_load_dwordx4 v9, s[8:11], s53 offen offset:1024 lds
    ds_read_b64_tr_b16 v[178:179], v146 offset:17408
    v_mfma_f32_16x16x32_bf16 v[120:123], v[68:71], v[208:211], v[120:123]
    ds_read_b64_tr_b16 v[180:181], v147 offset:16384
    ds_read_b64_tr_b16 v[182:183], v147 offset:17408
    v_mfma_f32_16x16x32_bf16 v[124:127], v[68:71], v[212:215], v[124:127]
    ds_read_b64_tr_b16 v[184:185], v148 offset:16384
    ds_read_b64_tr_b16 v[186:187], v148 offset:17408
    s_waitcnt lgkmcnt(11)
    v_mfma_f32_16x16x32_bf16 v[128:131], v[68:71], v[216:219], v[128:131]
    buffer_load_dwordx4 v10, s[8:11], s53 offen offset:2048 lds
    ds_read_b64_tr_b16 v[188:189], v149 offset:16384
    ds_read_b64_tr_b16 v[190:191], v149 offset:17408
    v_mfma_f32_16x16x32_bf16 v[132:135], v[68:71], v[220:223], v[132:135]
    ds_read_b64_tr_b16 v[192:193], v150 offset:16384
    ds_read_b64_tr_b16 v[194:195], v150 offset:17408
    v_mfma_f32_16x16x32_bf16 v[136:139], v[68:71], v[224:227], v[136:139]
    ds_read_b64_tr_b16 v[196:197], v151 offset:16384
    ds_read_b64_tr_b16 v[198:199], v151 offset:17408
    v_mfma_f32_16x16x32_bf16 v[140:143], v[68:71], v[228:231], v[140:143]
    buffer_load_dwordx4 v11, s[8:11], s53 offen offset:3072 lds
    s_add_u32 m0, s40, 16384
    s_add_u32 s52, s52, 128
    s_cmp_eq_u32 s52, 1280
    s_cselect_b32 s52, 0, s52
    ds_read_b128 v[76:79], v7 offset:10240
    ds_read_b64_tr_b16 v[200:201], v144 offset:24576
    ds_read_b64_tr_b16 v[202:203], v144 offset:25600
    s_waitcnt lgkmcnt(11)
    v_mfma_f32_16x16x32_bf16 v[112:115], v[72:75], v[168:171], v[112:115]
    ds_read_b64_tr_b16 v[204:205], v145 offset:24576
    ds_read_b64_tr_b16 v[206:207], v145 offset:25600
    v_mfma_f32_16x16x32_bf16 v[116:119], v[72:75], v[172:175], v[116:119]
    ds_read_b64_tr_b16 v[208:209], v146 offset:24576
    buffer_load_dwordx4 v4, s[4:7], s52 offen lds
    ds_read_b64_tr_b16 v[210:211], v146 offset:25600
    v_mfma_f32_16x16x32_bf16 v[120:123], v[72:75], v[176:179], v[120:123]
    ds_read_b64_tr_b16 v[212:213], v147 offset:24576
    ds_read_b64_tr_b16 v[214:215], v147 offset:25600
    v_mfma_f32_16x16x32_bf16 v[124:127], v[72:75], v[180:183], v[124:127]
    ds_read_b64_tr_b16 v[216:217], v148 offset:24576
    ds_read_b64_tr_b16 v[218:219], v148 offset:25600
    s_waitcnt lgkmcnt(11)
    v_mfma_f32_16x16x32_bf16 v[128:131], v[72:75], v[184:187], v[128:131]
    buffer_load_dwordx4 v5, s[4:7], s52 offen offset:1024 lds
    s_add_u32 m0, s62, 0
    s_mul_i32 s53, s52, 1536
    ds_read_b64_tr_b16 v[220:221], v149 offset:24576
    ds_read_b64_tr_b16 v[222:223], v149 offset:25600
    v_mfma_f32_16x16x32_bf16 v[132:135], v[72:75], v[188:191], v[132:135]
    ds_read_b64_tr_b16 v[224:225], v150 offset:24576
    ds_read_b64_tr_b16 v[226:227], v150 offset:25600
    v_mfma_f32_16x16x32_bf16 v[136:139], v[72:75], v[192:195], v[136:139]
    ds_read_b64_tr_b16 v[228:229], v151 offset:24576
    ds_read_b64_tr_b16 v[230:231], v151 offset:25600
    v_mfma_f32_16x16x32_bf16 v[140:143], v[72:75], v[196:199], v[140:143]
    s_waitcnt vmcnt(8)
    s_barrier
    buffer_load_dwordx4 v8, s[8:11], s53 offen lds
    ds_read_b128 v[80:83], v6 offset:12288
    ds_read_b64_tr_b16 v[168:169], v144 offset:32768
    ds_read_b64_tr_b16 v[170:171], v144 offset:33792
    s_waitcnt lgkmcnt(11)
    v_mfma_f32_16x16x32_bf16 v[112:115], v[76:79], v[200:203], v[112:115]
    ds_read_b64_tr_b16 v[172:173], v145 offset:32768
    ds_read_b64_tr_b16 v[174:175], v145 offset:33792
    v_mfma_f32_16x16x32_bf16 v[116:119], v[76:79], v[204:207], v[116:119]
    ds_read_b64_tr_b16 v[176:177], v146 offset:32768
    buffer_load_dwordx4 v9, s[8:11], s53 offen offset:1024 lds
    ds_read_b64_tr_b16 v[178:179], v146 offset:33792
    v_mfma_f32_16x16x32_bf16 v[120:123], v[76:79], v[208:211], v[120:123]
    ds_read_b64_tr_b16 v[180:181], v147 offset:32768
    ds_read_b64_tr_b16 v[182:183], v147 offset:33792
    v_mfma_f32_16x16x32_bf16 v[124:127], v[76:79], v[212:215], v[124:127]
    ds_read_b64_tr_b16 v[184:185], v148 offset:32768
    ds_read_b64_tr_b16 v[186:187], v148 offset:33792
    s_waitcnt lgkmcnt(11)
    v_mfma_f32_16x16x32_bf16 v[128:131], v[76:79], v[216:219], v[128:131]
    buffer_load_dwordx4 v10, s[8:11], s53 offen offset:2048 lds
    ds_read_b64_tr_b16 v[188:189], v149 offset:32768
    ds_read_b64_tr_b16 v[190:191], v149 offset:33792
    v_mfma_f32_16x16x32_bf16 v[132:135], v[76:79], v[220:223], v[132:135]
    ds_read_b64_tr_b16 v[192:193], v150 offset:32768
    ds_read_b64_tr_b16 v[194:195], v150 offset:33792
    v_mfma_f32_16x16x32_bf16 v[136:139], v[76:79], v[224:227], v[136:139]
    ds_read_b64_tr_b16 v[196:197], v151 offset:32768
    ds_read_b64_tr_b16 v[198:199], v151 offset:33792
    v_mfma_f32_16x16x32_bf16 v[140:143], v[76:79], v[228:231], v[140:143]
    buffer_load_dwordx4 v11, s[8:11], s53 offen offset:3072 lds
    s_add_u32 m0, s40, 18432
    s_add_u32 s52, s52, 128
    s_cmp_eq_u32 s52, 1280
    s_cselect_b32 s52, 0, s52
    ds_read_b128 v[84:87], v7 offset:12288
    ds_read_b64_tr_b16 v[200:201], v144 offset:40960
    ds_read_b64_tr_b16 v[202:203], v144 offset:41984
    s_waitcnt lgkmcnt(11)
    v_mfma_f32_16x16x32_bf16 v[112:115], v[80:83], v[168:171], v[112:115]
    ds_read_b64_tr_b16 v[204:205], v145 offset:40960
    ds_read_b64_tr_b16 v[206:207], v145 offset:41984
    v_mfma_f32_16x16x32_bf16 v[116:119], v[80:83], v[172:175], v[116:119]
    ds_read_b64_tr_b16 v[208:209], v146 offset:40960
    buffer_load_dwordx4 v4, s[4:7], s52 offen lds
    ds_read_b64_tr_b16 v[210:211], v146 offset:41984
    v_mfma_f32_16x16x32_bf16 v[120:123], v[80:83], v[176:179], v[120:123]
    ds_read_b64_tr_b16 v[212:213], v147 offset:40960
    ds_read_b64_tr_b16 v[214:215], v147 offset:41984
    v_mfma_f32_16x16x32_bf16 v[124:127], v[80:83], v[180:183], v[124:127]
    ds_read_b64_tr_b16 v[216:217], v148 offset:40960
    ds_read_b64_tr_b16 v[218:219], v148 offset:41984
    s_waitcnt lgkmcnt(11)
    v_mfma_f32_16x16x32_bf16 v[128:131], v[80:83], v[184:187], v[128:131]
    buffer_load_dwordx4 v5, s[4:7], s52 offen offset:1024 lds
    s_add_u32 m0, s62, 16384
    s_mul_i32 s53, s52, 1536
    ds_read_b64_tr_b16 v[220:221], v149 offset:40960
    ds_read_b64_tr_b16 v[222:223], v149 offset:41984
    v_mfma_f32_16x16x32_bf16 v[132:135], v[80:83], v[188:191], v[132:135]
    ds_read_b64_tr_b16 v[224:225], v150 offset:40960
    ds_read_b64_tr_b16 v[226:227], v150 offset:41984
    v_mfma_f32_16x16x32_bf16 v[136:139], v[80:83], v[192:195], v[136:139]
    ds_read_b64_tr_b16 v[228:229], v151 offset:40960
    ds_read_b64_tr_b16 v[230:231], v151 offset:41984
    v_mfma_f32_16x16x32_bf16 v[140:143], v[80:83], v[196:199], v[140:143]
    s_waitcnt vmcnt(8)
    s_barrier
    ds_read_b128 v[88:91], v6 offset:14336
    ds_read_b64_tr_b16 v[168:169], v144 offset:49152
    buffer_load_dwordx4 v8, s[8:11], s53 offen lds
    ds_read_b64_tr_b16 v[170:171], v144 offset:50176
    s_waitcnt lgkmcnt(11)
    v_mfma_f32_16x16x32_bf16 v[112:115], v[84:87], v[200:203], v[112:115]
    ds_read_b64_tr_b16 v[172:173], v145 offset:49152
    ds_read_b64_tr_b16 v[174:175], v145 offset:50176
    v_mfma_f32_16x16x32_bf16 v[116:119], v[84:87], v[204:207], v[116:119]
    ds_read_b64_tr_b16 v[176:177], v146 offset:49152
    ds_read_b64_tr_b16 v[178:179], v146 offset:50176
    v_mfma_f32_16x16x32_bf16 v[120:123], v[84:87], v[208:211], v[120:123]
    ds_read_b64_tr_b16 v[180:181], v147 offset:49152
    ds_read_b64_tr_b16 v[182:183], v147 offset:50176
    v_mfma_f32_16x16x32_bf16 v[124:127], v[84:87], v[212:215], v[124:127]
    ds_read_b64_tr_b16 v[184:185], v148 offset:49152
    buffer_load_dwordx4 v9, s[8:11], s53 offen offset:1024 lds
    ds_read_b64_tr_b16 v[186:187], v148 offset:50176
    s_waitcnt lgkmcnt(11)
    v_mfma_f32_16x16x32_bf16 v[128:131], v[84:87], v[216:219], v[128:131]
    ds_read_b64_tr_b16 v[188:189], v149 offset:49152
    ds_read_b64_tr_b16 v[190:191], v149 offset:50176
    v_mfma_f32_16x16x32_bf16 v[132:135], v[84:87], v[220:223], v[132:135]
    ds_read_b64_tr_b16 v[192:193], v150 offset:49152
    ds_read_b64_tr_b16 v[194:195], v150 offset:50176
    v_mfma_f32_16x16x32_bf16 v[136:139], v[84:87], v[224:227], v[136:139]
    ds_read_b64_tr_b16 v[196:197], v151 offset:49152
    ds_read_b64_tr_b16 v[198:199], v151 offset:50176
    v_mfma_f32_16x16x32_bf16 v[140:143], v[84:87], v[228:231], v[140:143]
    ds_read_b128 v[92:95], v7 offset:14336
    ds_read_b64_tr_b16 v[200:201], v144 offset:57344
    buffer_load_dwordx4 v10, s[8:11], s53 offen offset:2048 lds
    ds_read_b64_tr_b16 v[202:203], v144 offset:58368
    s_waitcnt lgkmcnt(11)
    v_mfma_f32_16x16x32_bf16 v[112:115], v[88:91], v[168:171], v[112:115]
    ds_read_b64_tr_b16 v[204:205], v145 offset:57344
    ds_read_b64_tr_b16 v[206:207], v145 offset:58368
    v_mfma_f32_16x16x32_bf16 v[116:119], v[88:91], v[172:175], v[116:119]
    ds_read_b64_tr_b16 v[208:209], v146 offset:57344
    ds_read_b64_tr_b16 v[210:211], v146 offset:58368
    v_mfma_f32_16x16x32_bf16 v[120:123], v[88:91], v[176:179], v[120:123]
    ds_read_b64_tr_b16 v[212:213], v147 offset:57344
    ds_read_b64_tr_b16 v[214:215], v147 offset:58368
    v_mfma_f32_16x16x32_bf16 v[124:127], v[88:91], v[180:183], v[124:127]
    ds_read_b64_tr_b16 v[216:217], v148 offset:57344
    buffer_load_dwordx4 v11, s[8:11], s53 offen offset:3072 lds
    s_add_u32 m0, s40, 20480
    s_add_u32 s38, s80, s88
    ds_read_b64_tr_b16 v[218:219], v148 offset:58368
    s_waitcnt lgkmcnt(11)
    v_mfma_f32_16x16x32_bf16 v[128:131], v[88:91], v[184:187], v[128:131]
    ds_read_b64_tr_b16 v[220:221], v149 offset:57344
    ds_read_b64_tr_b16 v[222:223], v149 offset:58368
    v_mfma_f32_16x16x32_bf16 v[132:135], v[88:91], v[188:191], v[132:135]
    ds_read_b64_tr_b16 v[224:225], v150 offset:57344
    buffer_load_dword v17, v255, s[24:27], s58 offen sc1
    ds_read_b64_tr_b16 v[226:227], v150 offset:58368
    v_mfma_f32_16x16x32_bf16 v[136:139], v[88:91], v[192:195], v[136:139]
    ds_read_b64_tr_b16 v[228:229], v151 offset:57344
    ds_read_b64_tr_b16 v[230:231], v151 offset:58368
    v_mfma_f32_16x16x32_bf16 v[140:143], v[88:91], v[196:199], v[140:143]
    s_waitcnt vmcnt(7)
    s_barrier
    ds_read_b128 v[96:99], v6 offset:16384
    ds_read_b64_tr_b16 v[168:169], v144 offset:0
    ds_read_b64_tr_b16 v[170:171], v144 offset:1024
    s_waitcnt lgkmcnt(11)
    v_mfma_f32_16x16x32_bf16 v[112:115], v[92:95], v[200:203], v[112:115]
    ds_read_b64_tr_b16 v[172:173], v145 offset:0
    ds_read_b64_tr_b16 v[174:175], v145 offset:1024
    v_mfma_f32_16x16x32_bf16 v[116:119], v[92:95], v[204:207], v[116:119]
    ds_read_b64_tr_b16 v[176:177], v146 offset:0
    ds_read_b64_tr_b16 v[178:179], v146 offset:1024
    v_mfma_f32_16x16x32_bf16 v[120:123], v[92:95], v[208:211], v[120:123]
    ds_read_b64_tr_b16 v[180:181], v147 offset:0
    ds_read_b64_tr_b16 v[182:183], v147 offset:1024
    v_mfma_f32_16x16x32_bf16 v[124:127], v[92:95], v[212:215], v[124:127]
    ds_read_b64_tr_b16 v[184:185], v148 offset:0
    ds_read_b64_tr_b16 v[186:187], v148 offset:1024
    s_waitcnt lgkmcnt(11)
    v_mfma_f32_16x16x32_bf16 v[128:131], v[92:95], v[216:219], v[128:131]
    buffer_store_dwordx4 v[152:155], v21, s[24:27], s98 offen offset:1024 sc1
    ds_read_b64_tr_b16 v[188:189], v149 offset:0
    ds_read_b64_tr_b16 v[190:191], v149 offset:1024
    v_mfma_f32_16x16x32_bf16 v[132:135], v[92:95], v[220:223], v[132:135]
    ds_read_b64_tr_b16 v[192:193], v150 offset:0
    ds_read_b64_tr_b16 v[194:195], v150 offset:1024
    v_mfma_f32_16x16x32_bf16 v[136:139], v[92:95], v[224:227], v[136:139]
    ds_read_b64_tr_b16 v[196:197], v151 offset:0
    ds_read_b64_tr_b16 v[198:199], v151 offset:1024
    v_mfma_f32_16x16x32_bf16 v[140:143], v[92:95], v[228:231], v[140:143]
    ds_read_b128 v[100:103], v7 offset:16384
    ds_read_b64_tr_b16 v[200:201], v144 offset:8192
    ds_read_b64_tr_b16 v[202:203], v144 offset:9216
    s_waitcnt lgkmcnt(11)
    v_mfma_f32_16x16x32_bf16 v[112:115], v[96:99], v[168:171], v[112:115]
    buffer_store_dwordx4 v[152:155], v21, s[24:27], s98 offen offset:2048 sc1
    ds_read_b64_tr_b16 v[204:205], v145 offset:8192
    ds_read_b64_tr_b16 v[206:207], v145 offset:9216
    v_mfma_f32_16x16x32_bf16 v[116:119], v[96:99], v[172:175], v[116:119]
    ds_read_b64_tr_b16 v[208:209], v146 offset:8192
    ds_read_b64_tr_b16 v[210:211], v146 offset:9216
    v_mfma_f32_16x16x32_bf16 v[120:123], v[96:99], v[176:179], v[120:123]
    ds_read_b64_tr_b16 v[212:213], v147 offset:8192
    ds_read_b64_tr_b16 v[214:215], v147 offset:9216
    v_mfma_f32_16x16x32_bf16 v[124:127], v[96:99], v[180:183], v[124:127]
    ds_read_b64_tr_b16 v[216:217], v148 offset:8192
    ds_read_b64_tr_b16 v[218:219], v148 offset:9216
    s_waitcnt lgkmcnt(11)
    v_mfma_f32_16x16x32_bf16 v[128:131], v[96:99], v[184:187], v[128:131]
    ds_read_b64_tr_b16 v[220:221], v149 offset:8192
    ds_read_b64_tr_b16 v[222:223], v149 offset:9216
    buffer_store_dwordx4 v[152:155], v21, s[24:27], s100 offen offset:0 sc1
    v_mfma_f32_16x16x32_bf16 v[132:135], v[96:99], v[188:191], v[132:135]
    ds_read_b64_tr_b16 v[224:225], v150 offset:8192
    ds_read_b64_tr_b16 v[226:227], v150 offset:9216
    v_mfma_f32_16x16x32_bf16 v[136:139], v[96:99], v[192:195], v[136:139]
    ds_read_b64_tr_b16 v[228:229], v151 offset:8192
    ds_read_b64_tr_b16 v[230:231], v151 offset:9216
    v_mfma_f32_16x16x32_bf16 v[140:143], v[96:99], v[196:199], v[140:143]
    s_waitcnt vmcnt(4)
    s_barrier
    ds_read_b128 v[104:107], v6 offset:18432
    ds_read_b64_tr_b16 v[168:169], v144 offset:16384
    buffer_load_dwordx4 v13, s[12:15], s38 offen lds
    ds_read_b64_tr_b16 v[170:171], v144 offset:17408
    s_waitcnt lgkmcnt(11)
    v_mfma_f32_16x16x32_bf16 v[112:115], v[100:103], v[200:203], v[112:115]
    ds_read_b64_tr_b16 v[172:173], v145 offset:16384
    ds_read_b64_tr_b16 v[174:175], v145 offset:17408
    v_mfma_f32_16x16x32_bf16 v[116:119], v[100:103], v[204:207], v[116:119]
    ds_read_b64_tr_b16 v[176:177], v146 offset:16384
    ds_read_b64_tr_b16 v[178:179], v146 offset:17408
    v_mfma_f32_16x16x32_bf16 v[120:123], v[100:103], v[208:211], v[120:123]
    ds_read_b64_tr_b16 v[180:181], v147 offset:16384
    ds_read_b64_tr_b16 v[182:183], v147 offset:17408
    v_mfma_f32_16x16x32_bf16 v[124:127], v[100:103], v[212:215], v[124:127]
    ds_read_b64_tr_b16 v[184:185], v148 offset:16384
    ds_read_b64_tr_b16 v[186:187], v148 offset:17408
    s_waitcnt lgkmcnt(11)
    v_mfma_f32_16x16x32_bf16 v[128:131], v[100:103], v[216:219], v[128:131]
    buffer_load_dwordx4 v14, s[12:15], s38 offen offset:1024 lds
    s_add_u32 m0, s40, 22528
    s_add_u32 s38, s80, s89
    ds_read_b64_tr_b16 v[188:189], v149 offset:16384
    ds_read_b64_tr_b16 v[190:191], v149 offset:17408
    v_mfma_f32_16x16x32_bf16 v[132:135], v[100:103], v[220:223], v[132:135]
    ds_read_b64_tr_b16 v[192:193], v150 offset:16384
    ds_read_b64_tr_b16 v[194:195], v150 offset:17408
    v_mfma_f32_16x16x32_bf16 v[136:139], v[100:103], v[224:227], v[136:139]
    ds_read_b64_tr_b16 v[196:197], v151 offset:16384
    ds_read_b64_tr_b16 v[198:199], v151 offset:17408
    v_mfma_f32_16x16x32_bf16 v[140:143], v[100:103], v[228:231], v[140:143]
    ds_read_b128 v[108:111], v7 offset:18432
    ds_read_b64_tr_b16 v[200:201], v144 offset:24576
    ds_read_b64_tr_b16 v[202:203], v144 offset:25600
    s_waitcnt lgkmcnt(11)
    v_mfma_f32_16x16x32_bf16 v[112:115], v[104:107], v[168:171], v[112:115]
    ds_read_b64_tr_b16 v[204:205], v145 offset:24576
    buffer_load_dwordx4 v13, s[12:15], s38 offen lds
    ds_read_b64_tr_b16 v[206:207], v145 offset:25600
    v_mfma_f32_16x16x32_bf16 v[116:119], v[104:107], v[172:175], v[116:119]
    ds_read_b64_tr_b16 v[208:209], v146 offset:24576
    ds_read_b64_tr_b16 v[210:211], v146 offset:25600
    v_mfma_f32_16x16x32_bf16 v[120:123], v[104:107], v[176:179], v[120:123]
    ds_read_b64_tr_b16 v[212:213], v147 offset:24576
    ds_read_b64_tr_b16 v[214:215], v147 offset:25600
    v_mfma_f32_16x16x32_bf16 v[124:127], v[104:107], v[180:183], v[124:127]
    ds_read_b64_tr_b16 v[216:217], v148 offset:24576
    ds_read_b64_tr_b16 v[218:219], v148 offset:25600
    s_waitcnt lgkmcnt(11)
    v_mfma_f32_16x16x32_bf16 v[128:131], v[104:107], v[184:187], v[128:131]
    ds_read_b64_tr_b16 v[220:221], v149 offset:24576
    ds_read_b64_tr_b16 v[222:223], v149 offset:25600
    v_mfma_f32_16x16x32_bf16 v[132:135], v[104:107], v[188:191], v[132:135]
    ds_read_b64_tr_b16 v[224:225], v150 offset:24576
    buffer_load_dwordx4 v14, s[12:15], s38 offen offset:1024 lds
    s_add_u32 m0, s41, 36864
    ds_read_b64_tr_b16 v[226:227], v150 offset:25600
    v_mfma_f32_16x16x32_bf16 v[136:139], v[104:107], v[192:195], v[136:139]
    ds_read_b64_tr_b16 v[228:229], v151 offset:24576
    ds_read_b64_tr_b16 v[230:231], v151 offset:25600
    v_mfma_f32_16x16x32_bf16 v[140:143], v[104:107], v[196:199], v[140:143]
    s_waitcnt lgkmcnt(12)
    v_mfma_f32_16x16x32_bf16 v[112:115], v[108:111], v[200:203], v[112:115]
    v_mfma_f32_16x16x32_bf16 v[116:119], v[108:111], v[204:207], v[116:119]
    s_waitcnt lgkmcnt(8)
    v_mfma_f32_16x16x32_bf16 v[120:123], v[108:111], v[208:211], v[120:123]
    v_mfma_f32_16x16x32_bf16 v[124:127], v[108:111], v[212:215], v[124:127]
    s_waitcnt lgkmcnt(4)
    v_mfma_f32_16x16x32_bf16 v[128:131], v[108:111], v[216:219], v[128:131]
    v_mfma_f32_16x16x32_bf16 v[132:135], v[108:111], v[220:223], v[132:135]
    s_waitcnt lgkmcnt(0)
    v_mfma_f32_16x16x32_bf16 v[136:139], v[108:111], v[224:227], v[136:139]
    v_mfma_f32_16x16x32_bf16 v[140:143], v[108:111], v[228:231], v[140:143]
    s_mul_i32 s35, s35, 1664525
    s_add_u32 s35, s35, 1013904223
    v_mov_b32 v28, s35
    v_mov_b32 v29, s35
    v_mov_b32 v30, s35
    v_mov_b32 v31, s35
    s_waitcnt vmcnt(7)
    s_mov_b32 s39, 0
L_h0_chk:
    v_cmp_ne_u32 vcc, s35, v17
    s_cmp_lg_u64 vcc, 0
    s_cbranch_scc0 L_h0_ok
    s_add_u32 s39, s39, 1
    s_cmp_lt_u32 s39, 400000
    s_cbranch_scc0 L_h0_ok
    buffer_load_dword v17, v255, s[24:27], s58 offen sc1
    s_waitcnt vmcnt(0)
    s_branch L_h0_chk
L_h0_ok:
    s_barrier
    buffer_load_dwordx4 v12, s[24:27], s57 offen sc1 lds
    v_pk_mul_f32 v[168:169], v[112:113], v[112:113]
    v_pk_mul_f32 v[170:171], v[114:115], v[114:115]
    v_pk_mul_f32 v[172:173], v[116:117], v[116:117]
    v_pk_mul_f32 v[174:175], v[118:119], v[118:119]
    v_pk_mul_f32 v[176:177], v[120:121], v[120:121]
    v_pk_mul_f32 v[178:179], v[122:123], v[122:123]
    v_pk_mul_f32 v[180:181], v[124:125], v[124:125]
L_page2:
    s_cbranch_execz L_ret0
    v_pk_mul_f32 v[182:183], v[126:127], v[126:127]
    v_pk_mul_f32 v[184:185], v[128:129], v[128:129]
    v_pk_mul_f32 v[186:187], v[130:131], v[130:131]
    v_pk_mul_f32 v[188:189], v[132:133], v[132:133]
    buffer_load_dwordx4 v12, s[24:27], s57 offen offset:1024 sc1 lds
    v_pk_mul_f32 v[190:191], v[134:135], v[134:135]
    v_pk_mul_f32 v[192:193], v[136:137], v[136:137]
    v_pk_mul_f32 v[194:195], v[138:139], v[138:139]
    v_pk_mul_f32 v[196:197], v[140:141], v[140:141]
    v_pk_mul_f32 v[198:199], v[142:143], v[142:143]
    v_pk_fma_f32 v[168:169], v[168:169], s[46:47], v[2:3]
    v_pk_fma_f32 v[170:171], v[170:171], s[46:47], v[2:3]
    v_pk_fma_f32 v[172:173], v[172:173], s[46:47], v[2:3]
    v_pk_fma_f32 v[174:175], v[174:175], s[46:47], v[2:3]
    v_pk_fma_f32 v[176:177], v[176:177], s[46:47], v[2:3]
    v_pk_fma_f32 v[178:179], v[178:179], s[46:47], v[2:3]
    v_pk_fma_f32 v[180:181], v[180:181], s[46:47], v[2:3]
    v_pk_fma_f32 v[182:183], v[182:183], s[46:47], v[2:3]
    buffer_load_dwordx4 v12, s[24:27], s57 offen offset:2048 sc1 lds
    s_add_u32 m0, s40, 0
    s_add_u32 s38, s80, s90
    v_pk_fma_f32 v[184:185], v[184:185], s[46:47], v[2:3]
    v_pk_fma_f32 v[186:187], v[186:187], s[46:47], v[2:3]
    v_pk_fma_f32 v[188:189], v[188:189], s[46:47], v[2:3]
    v_pk_fma_f32 v[190:191], v[190:191], s[46:47], v[2:3]
    v_pk_fma_f32 v[192:193], v[192:193], s[46:47], v[2:3]
    v_pk_fma_f32 v[194:195], v[194:195], s[46:47], v[2:3]
    v_pk_fma_f32 v[196:197], v[196:197], s[46:47], v[2:3]
    v_pk_fma_f32 v[198:199], v[198:199], s[46:47], v[2:3]
    v_pk_mul_f32 v[168:169], v[168:169], v[112:113]
    v_pk_mul_f32 v[170:171], v[170:171], v[114:115]
    v_pk_mul_f32 v[172:173], v[172:173], v[116:117]
    v_pk_mul_f32 v[174:175], v[174:175], v[118:119]
    v_pk_mul_f32 v[176:177], v[176:177], v[120:121]
    buffer_load_dwordx4 v13, s[12:15], s38 offen lds
    v_pk_mul_f32 v[178:179], v[178:179], v[122:123]
    v_pk_mul_f32 v[180:181], v[180:181], v[124:125]
    v_pk_mul_f32 v[182:183], v[182:183], v[126:127]
    v_pk_mul_f32 v[184:185], v[184:185], v[128:129]
    v_pk_mul_f32 v[186:187], v[186:187], v[130:131]
    v_pk_mul_f32 v[188:189], v[188:189], v[132:133]
    v_pk_mul_f32 v[190:191], v[190:191], v[134:135]
    v_pk_mul_f32 v[192:193], v[192:193], v[136:137]
    v_pk_mul_f32 v[194:195], v[194:195], v[138:139]
    v_pk_mul_f32 v[196:197], v[196:197], v[140:141]
    v_pk_mul_f32 v[198:199], v[198:199], v[142:143]
    v_exp_f32 v168, v168
    buffer_load_dwordx4 v14, s[12:15], s38 offen offset:1024 lds
    s_add_u32 m0, s41, 49152
    s_add_u32 s57, s57, 98304
    s_cmp_eq_u32 s57, 983040
    s_cselect_b32 s57, 0, s57
    v_exp_f32 v169, v169
    v_exp_f32 v170, v170
    v_exp_f32 v171, v171
    v_exp_f32 v172, v172
    v_exp_f32 v173, v173
    v_exp_f32 v174, v174
    buffer_load_dwordx4 v12, s[24:27], s57 offen sc1 lds
    v_exp_f32 v175, v175
    v_exp_f32 v176, v176
    v_exp_f32 v177, v177
    v_exp_f32 v178, v178
    v_exp_f32 v179, v179
    v_exp_f32 v180, v180
    v_exp_f32 v181, v181
    buffer_load_dwordx4 v12, s[24:27], s57 offen offset:1024 sc1 lds
    v_exp_f32 v182, v182
    v_exp_f32 v183, v183
    v_exp_f32 v184, v184
    v_exp_f32 v185, v185
    v_exp_f32 v186, v186
    v_exp_f32 v187, v187
    buffer_load_dwordx4 v12, s[24:27], s57 offen offset:2048 sc1 lds
    s_add_u32 m0, s40, 2048
    s_add_u32 s38, s80, s91
    v_exp_f32 v188, v188
    v_exp_f32 v189, v189
    v_exp_f32 v190, v190
    v_exp_f32 v191, v191
    v_exp_f32 v192, v192
    v_exp_f32 v193, v193
    v_exp_f32 v194, v194
    buffer_load_dwordx4 v13, s[12:15], s38 offen lds
    v_exp_f32 v195, v195
    v_exp_f32 v196, v196
    v_exp_f32 v197, v197
    v_exp_f32 v198, v198
    v_exp_f32 v199, v199
    v_pk_add_f32 v[168:169], v[168:169], 1.0 op_sel_hi:[1,0]
    v_pk_add_f32 v[170:171], v[170:171], 1.0 op_sel_hi:[1,0]
    buffer_load_dwordx4 v14, s[12:15], s38 offen offset:1024 lds
    s_add_u32 m0, s40, 4096
    s_add_u32 s38, s81, s88
    v_pk_add_f32 v[172:173], v[172:173], 1.0 op_sel_hi:[1,0]
    v_pk_add_f32 v[174:175], v[174:175], 1.0 op_sel_hi:[1,0]
    v_pk_add_f32 v[176:177], v[176:177], 1.0 op_sel_hi:[1,0]
    v_pk_add_f32 v[178:179], v[178:179], 1.0 op_sel_hi:[1,0]
    v_pk_add_f32 v[180:181], v[180:181], 1.0 op_sel_hi:[1,0]
    v_pk_add_f32 v[182:183], v[182:183], 1.0 op_sel_hi:[1,0]
    v_pk_add_f32 v[184:185], v[184:185], 1.0 op_sel_hi:[1,0]
    v_pk_add_f32 v[186:187], v[186:187], 1.0 op_sel_hi:[1,0]
    v_pk_add_f32 v[188:189], v[188:189], 1.0 op_sel_hi:[1,0]
    v_pk_add_f32 v[190:191], v[190:191], 1.0 op_sel_hi:[1,0]
    v_pk_add_f32 v[192:193], v[192:193], 1.0 op_sel_hi:[1,0]
    v_pk_add_f32 v[194:195], v[194:195], 1.0 op_sel_hi:[1,0]
    v_pk_add_f32 v[196:197], v[196:197], 1.0 op_sel_hi:[1,0]
    buffer_load_dwordx4 v13, s[12:15], s38 offen lds
    v_pk_add_f32 v[198:199], v[198:199], 1.0 op_sel_hi:[1,0]
    v_rcp_f32 v168, v168
    v_rcp_f32 v169, v169
    v_rcp_f32 v170, v170
    v_rcp_f32 v171, v171
    v_rcp_f32 v172, v172
    v_rcp_f32 v173, v173
    buffer_load_dwordx4 v14, s[12:15], s38 offen offset:1024 lds
    s_add_u32 m0, s41, 0
    s_add_u32 s57, s57, 98304
    s_cmp_eq_u32 s57, 983040
    s_cselect_b32 s57, 0, s57
    v_rcp_f32 v174, v174
    v_rcp_f32 v175, v175
    v_rcp_f32 v176, v176
    v_rcp_f32 v177, v177
    v_rcp_f32 v178, v178
    v_rcp_f32 v179, v179
    buffer_load_dwordx4 v12, s[24:27], s57 offen sc1 lds
    v_rcp_f32 v180, v180
    v_rcp_f32 v181, v181
    v_rcp_f32 v182, v182
    v_rcp_f32 v183, v183
    v_rcp_f32 v184, v184
    v_rcp_f32 v185, v185
    v_rcp_f32 v186, v186
    buffer_load_dwordx4 v12, s[24:27], s57 offen offset:1024 sc1 lds
    v_rcp_f32 v187, v187
    v_rcp_f32 v188, v188
    v_rcp_f32 v189, v189
    v_rcp_f32 v190, v190
    v_rcp_f32 v191, v191
    v_rcp_f32 v192, v192
    buffer_load_dwordx4 v12, s[24:27], s57 offen offset:2048 sc1 lds
    s_add_u32 m0, s40, 6144
    s_add_u32 s38, s81, s89
    v_rcp_f32 v193, v193
    v_rcp_f32 v194, v194
    v_rcp_f32 v195, v195
    v_rcp_f32 v196, v196
    v_rcp_f32 v197, v197
    v_rcp_f32 v198, v198
    v_rcp_f32 v199, v199
    buffer_load_dwordx4 v13, s[12:15], s38 offen lds
    v_pk_mul_f32 v[112:113], v[112:113], v[168:169]
    v_pk_mul_f32 v[114:115], v[114:115], v[170:171]
    v_pk_mul_f32 v[116:117], v[116:117], v[172:173]
    v_pk_mul_f32 v[118:119], v[118:119], v[174:175]
    v_pk_mul_f32 v[120:121], v[120:121], v[176:177]
    v_pk_mul_f32 v[122:123], v[122:123], v[178:179]
    v_pk_mul_f32 v[124:125], v[124:125], v[180:181]
    v_pk_mul_f32 v[126:127], v[126:127], v[182:183]
    v_pk_mul_f32 v[128:129], v[128:129], v[184:185]
    v_pk_mul_f32 v[130:131], v[130:131], v[186:187]
    v_pk_mul_f32 v[132:133], v[132:133], v[188:189]
    v_pk_mul_f32 v[134:135], v[134:135], v[190:191]
    buffer_load_dwordx4 v14, s[12:15], s38 offen offset:1024 lds
    s_add_u32 m0, s41, 12288
    s_add_u32 s57, s57, 98304
    s_cmp_eq_u32 s57, 983040
    s_cselect_b32 s57, 0, s57
    v_pk_mul_f32 v[136:137], v[136:137], v[192:193]
    v_pk_mul_f32 v[138:139], v[138:139], v[194:195]
    v_pk_mul_f32 v[140:141], v[140:141], v[196:197]
    v_pk_mul_f32 v[142:143], v[142:143], v[198:199]
    v_pk_add_f32 v[232:233], v[112:113], v[116:117]
    v_pk_mul_f32 v[236:237], v[112:113], v[112:113]
    v_pk_add_f32 v[234:235], v[114:115], v[118:119]
    v_pk_mul_f32 v[238:239], v[114:115], v[114:115]
    v_pk_fma_f32 v[236:237], v[116:117], v[116:117], v[236:237]
    v_pk_fma_f32 v[238:239], v[118:119], v[118:119], v[238:239]
    v_pk_add_f32 v[232:233], v[232:233], v[120:121]
    v_pk_fma_f32 v[236:237], v[120:121], v[120:121], v[236:237]
    v_pk_add_f32 v[234:235], v[234:235], v[122:123]
    buffer_load_dwordx4 v12, s[24:27], s57 offen sc1 lds
    v_pk_fma_f32 v[238:239], v[122:123], v[122:123], v[238:239]
    v_pk_add_f32 v[232:233], v[232:233], v[124:125]
    v_pk_fma_f32 v[236:237], v[124:125], v[124:125], v[236:237]
    v_pk_add_f32 v[234:235], v[234:235], v[126:127]
    v_pk_fma_f32 v[238:239], v[126:127], v[126:127], v[238:239]
    v_pk_add_f32 v[232:233], v[232:233], v[128:129]
    v_pk_fma_f32 v[236:237], v[128:129], v[128:129], v[236:237]
    v_pk_add_f32 v[234:235], v[234:235], v[130:131]
    v_pk_fma_f32 v[238:239], v[130:131], v[130:131], v[238:239]
    v_pk_add_f32 v[232:233], v[232:233], v[132:133]
    v_pk_fma_f32 v[236:237], v[132:133], v[132:133], v[236:237]
    v_pk_add_f32 v[234:235], v[234:235], v[134:135]
    v_pk_fma_f32 v[238:239], v[134:135], v[134:135], v[238:239]
    buffer_load_dwordx4 v12, s[24:27], s57 offen offset:1024 sc1 lds
    v_pk_add_f32 v[232:233], v[232:233], v[136:137]
    v_pk_fma_f32 v[236:237], v[136:137], v[136:137], v[236:237]
    v_pk_add_f32 v[234:235], v[234:235], v[138:139]
    v_pk_fma_f32 v[238:239], v[138:139], v[138:139], v[238:239]
    v_pk_add_f32 v[232:233], v[232:233], v[140:141]
    v_pk_fma_f32 v[236:237], v[140:141], v[140:141], v[236:237]
    v_pk_add_f32 v[234:235], v[234:235], v[142:143]
    v_pk_fma_f32 v[238:239], v[142:143], v[142:143], v[238:239]
    v_cndmask_b32 v240, v233, v232, s[42:43]
    v_cndmask_b32 v242, v235, v234, s[42:43]
    v_cndmask_b32 v244, v237, v236, s[42:43]
    v_cndmask_b32 v246, v239, v238, s[42:43]
    buffer_load_dwordx4 v12, s[24:27], s57 offen offset:2048 sc1 lds
    s_add_u32 m0, s40, 8192
    s_add_u32 s38, s81, s90
    v_cndmask_b32 v241, v232, v233, s[42:43]
    v_cndmask_b32 v243, v234, v235, s[42:43]
    v_cndmask_b32 v245, v236, v237, s[42:43]
    v_cndmask_b32 v247, v238, v239, s[42:43]
    v_add_f32_dpp v232, v240, v241 quad_perm:[1,0,3,2] row_mask:0xf bank_mask:0xf
    v_add_f32_dpp v233, v242, v243 quad_perm:[1,0,3,2] row_mask:0xf bank_mask:0xf
    v_add_f32_dpp v234, v244, v245 quad_perm:[1,0,3,2] row_mask:0xf bank_mask:0xf
    v_add_f32_dpp v235, v246, v247 quad_perm:[1,0,3,2] row_mask:0xf bank_mask:0xf
    v_cndmask_b32 v240, v233, v232, s[44:45]
    v_cndmask_b32 v242, v235, v234, s[44:45]
    v_cndmask_b32 v241, v232, v233, s[44:45]
    v_cndmask_b32 v243, v234, v235, s[44:45]
    s_nop 0
    v_add_f32_dpp v232, v240, v241 quad_perm:[2,3,0,1] row_mask:0xf bank_mask:0xf
    v_add_f32_dpp v233, v242, v243 quad_perm:[2,3,0,1] row_mask:0xf bank_mask:0xf
    v_mov_b32 v253, s35
    v_add_f32_dpp v234, v232, v232 row_ror:4 row_mask:0xf bank_mask:0xf
    v_add_f32_dpp v235, v233, v233 row_ror:4 row_mask:0xf bank_mask:0xf
    v_mov_b32 v255, s35
    v_add_f32_dpp v252, v234, v234 row_ror:8 row_mask:0xf bank_mask:0xf
    v_add_f32_dpp v254, v235, v235 row_ror:8 row_mask:0xf bank_mask:0xf
    s_waitcnt vmcnt(24)
    s_mov_b32 exec_lo, 0x000f000f
    s_mov_b32 exec_hi, 0x000f000f
    buffer_store_dwordx4 v[252:255], v15, s[24:27], 0 offen sc1
    s_mov_b64 exec, -1
    s_waitcnt vmcnt(18)
    s_barrier
    ds_read_b128 v[168:171], v21 offset:36864
    buffer_load_dwordx4 v13, s[12:15], s38 offen lds
    ds_read_b128 v[172:175], v21 offset:37888
    ds_read_b128 v[176:179], v21 offset:38912
    ds_read_b128 v[180:183], v21 offset:39936
    ds_read_b128 v[184:187], v21 offset:40960
    buffer_load_dwordx4 v14, s[12:15], s38 offen offset:1024 lds
    s_add_u32 m0, s40, 10240
    s_add_u32 s38, s81, s91
    ds_read_b128 v[188:191], v21 offset:41984
    ds_read_b128 v[200:203], v21 offset:43008
    s_waitcnt lgkmcnt(4)
    v_mfma_f32_16x16x32_bf16 v[144:147], v[168:171], v[32:35], 0
    ds_read_b128 v[204:207], v21 offset:44032
    v_mfma_f32_16x16x32_bf16 v[148:151], v[172:175], v[32:35], 0
    buffer_load_dwordx4 v13, s[12:15], s38 offen lds
    ds_read_b128 v[208:211], v21 offset:45056
    v_mfma_f32_16x16x32_bf16 v[152:155], v[176:179], v[32:35], 0
    ds_read_b128 v[212:215], v21 offset:46080
    s_waitcnt lgkmcnt(4)
    v_mfma_f32_16x16x32_bf16 v[156:159], v[180:183], v[32:35], 0
    buffer_load_dwordx4 v14, s[12:15], s38 offen offset:1024 lds
    s_add_u32 m0, s40, 12288
    s_add_u32 s38, s82, s88
    ds_read_b128 v[216:219], v21 offset:47104
    v_mfma_f32_16x16x32_bf16 v[160:163], v[184:187], v[32:35], 0
    ds_read_b128 v[220:223], v21 offset:48128
    v_mfma_f32_16x16x32_bf16 v[164:167], v[188:191], v[32:35], 0
    s_waitcnt vmcnt(17)
    s_barrier
    ds_read_b128 v[168:171], v21 offset:49152
    buffer_load_dwordx4 v13, s[12:15], s38 offen lds
    s_waitcnt lgkmcnt(4)
    v_mfma_f32_16x16x32_bf16 v[144:147], v[200:203], v[36:39], v[144:147]
    ds_read_b128 v[172:175], v21 offset:50176
    v_mfma_f32_16x16x32_bf16 v[148:151], v[204:207], v[36:39], v[148:151]
    buffer_load_dwordx4 v14, s[12:15], s38 offen offset:1024 lds
    s_add_u32 m0, s40, 14336
    s_add_u32 s38, s82, s89
    ds_read_b128 v[176:179], v21 offset:51200
    v_mfma_f32_16x16x32_bf16 v[152:155], v[208:211], v[36:39], v[152:155]
    ds_read_b128 v[180:183], v21 offset:52224
    buffer_load_dwordx4 v13, s[12:15], s38 offen lds
    s_waitcnt lgkmcnt(4)
    v_mfma_f32_16x16x32_bf16 v[156:159], v[212:215], v[36:39], v[156:159]
    ds_read_b128 v[184:187], v21 offset:53248
    v_mfma_f32_16x16x32_bf16 v[160:163], v[216:219], v[36:39], v[160:163]
    ds_read_b128 v[188:191], v21 offset:54272
    buffer_load_dwordx4 v14, s[12:15], s38 offen offset:1024 lds
    s_add_u32 m0, s41, 24576
    s_add_u32 s57, s57, 98304
    s_cmp_eq_u32 s57, 983040
    s_cselect_b32 s57, 0, s57
    v_mfma_f32_16x16x32_bf16 v[164:167], v[220:223], v[36:39], v[164:167]
    ds_read_b128 v[200:203], v21 offset:55296
    s_waitcnt lgkmcnt(4)
    v_mfma_f32_16x16x32_bf16 v[144:147], v[168:171], v[40:43], v[144:147]
    buffer_load_dwordx4 v12, s[24:27], s57 offen sc1 lds
    ds_read_b128 v[204:207], v21 offset:56320
    v_mfma_f32_16x16x32_bf16 v[148:151], v[172:175], v[40:43], v[148:151]
    ds_read_b128 v[208:211], v21 offset:57344
    v_mfma_f32_16x16x32_bf16 v[152:155], v[176:179], v[40:43], v[152:155]
    buffer_load_dwordx4 v12, s[24:27], s57 offen offset:1024 sc1 lds
    ds_read_b128 v[212:215], v21 offset:58368
    s_waitcnt lgkmcnt(4)
    v_mfma_f32_16x16x32_bf16 v[156:159], v[180:183], v[40:43], v[156:159]
    ds_read_b128 v[216:219], v21 offset:59392
    buffer_load_dwordx4 v12, s[24:27], s57 offen offset:2048 sc1 lds
    s_add_u32 m0, s40, 16384
    s_add_u32 s38, s82, s90
    v_mfma_f32_16x16x32_bf16 v[160:163], v[184:187], v[40:43], v[160:163]
    ds_read_b128 v[220:223], v21 offset:60416
    v_mfma_f32_16x16x32_bf16 v[164:167], v[188:191], v[40:43], v[164:167]
    s_waitcnt vmcnt(17)
    s_barrier
    ds_read_b128 a[0:3], v6 offset:20480
    ds_read_b128 v[168:171], v21 offset:0
    s_waitcnt lgkmcnt(5)
    v_mfma_f32_16x16x32_bf16 v[144:147], v[200:203], v[44:47], v[144:147]
    buffer_load_dwordx4 v13, s[12:15], s38 offen lds
    ds_read_b128 v[172:175], v21 offset:1024
    v_mfma_f32_16x16x32_bf16 v[148:151], v[204:207], v[44:47], v[148:151]
    ds_read_b128 a[16:19], v7 offset:20480
    ds_read_b128 v[176:179], v21 offset:2048
    v_mfma_f32_16x16x32_bf16 v[152:155], v[208:211], v[44:47], v[152:155]
    ds_read_b128 v[180:183], v21 offset:3072
    buffer_load_dwordx4 v14, s[12:15], s38 offen offset:1024 lds
    s_add_u32 m0, s40, 18432
    s_add_u32 s38, s82, s91
    s_waitcnt lgkmcnt(6)
    v_mfma_f32_16x16x32_bf16 v[156:159], v[212:215], v[44:47], v[156:159]
    ds_read_b128 a[4:7], v6 offset:22528
    ds_read_b128 v[184:187], v21 offset:4096
    v_mfma_f32_16x16x32_bf16 v[160:163], v[216:219], v[44:47], v[160:163]
    ds_read_b128 v[188:191], v21 offset:5120
    buffer_load_dwordx4 v13, s[12:15], s38 offen lds
    v_mfma_f32_16x16x32_bf16 v[164:167], v[220:223], v[44:47], v[164:167]
    ds_read_b128 v[200:203], v21 offset:6144
    ds_read_b128 a[20:23], v7 offset:22528
    s_waitcnt lgkmcnt(6)
    v_mfma_f32_16x16x32_bf16 v[144:147], v[168:171], v[48:51], v[144:147]
    ds_read_b128 v[204:207], v21 offset:7168
    buffer_load_dwordx4 v14, s[12:15], s38 offen offset:1024 lds
    s_add_u32 m0, s41, 36864
    s_add_u32 s57, s57, 98304
    s_cmp_eq_u32 s57, 983040
    s_cselect_b32 s57, 0, s57
    v_mfma_f32_16x16x32_bf16 v[148:151], v[172:175], v[48:51], v[148:151]
    ds_read_b128 v[208:211], v21 offset:8192
    buffer_load_dwordx4 v12, s[24:27], s57 offen sc1 lds
    v_mfma_f32_16x16x32_bf16 v[152:155], v[176:179], v[48:51], v[152:155]
    ds_read_b128 v[212:215], v21 offset:9216
    buffer_load_dwordx4 v12, s[24:27], s57 offen offset:1024 sc1 lds
    buffer_load_dwordx4 v[232:235], v18, s[24:27], 0 offen sc1
    buffer_load_dwordx4 v[236:239], v18, s[24:27], 0 offen offset:1024 sc1
    s_waitcnt lgkmcnt(5)
    v_mfma_f32_16x16x32_bf16 v[156:159], v[180:183], v[48:51], v[156:159]
    ds_read_b128 v[216:219], v21 offset:10240
    v_mfma_f32_16x16x32_bf16 v[160:163], v[184:187], v[48:51], v[160:163]
    buffer_load_dwordx4 v12, s[24:27], s57 offen offset:2048 sc1 lds
    s_add_u32 m0, s40, 20480
    s_add_u32 s38, s83, s88
    ds_read_b128 v[220:223], v21 offset:11264
    v_mfma_f32_16x16x32_bf16 v[164:167], v[188:191], v[48:51], v[164:167]
    s_waitcnt vmcnt(21)
    s_barrier
    ds_read_b128 a[8:11], v6 offset:0
    ds_read_b128 v[168:171], v21 offset:12288
    s_waitcnt lgkmcnt(5)
    v_mfma_f32_16x16x32_bf16 v[144:147], v[200:203], v[52:55], v[144:147]
    buffer_load_dwordx4 v13, s[12:15], s38 offen lds
    ds_read_b128 v[172:175], v21 offset:13312
    v_mfma_f32_16x16x32_bf16 v[148:151], v[204:207], v[52:55], v[148:151]
    ds_read_b128 a[24:27], v7 offset:0
    ds_read_b128 v[176:179], v21 offset:14336
    v_mfma_f32_16x16x32_bf16 v[152:155], v[208:211], v[52:55], v[152:155]
    ds_read_b128 v[180:183], v21 offset:15360
    buffer_load_dwordx4 v14, s[12:15], s38 offen offset:1024 lds
    s_add_u32 m0, s40, 22528
    s_add_u32 s38, s83, s89
    s_waitcnt lgkmcnt(6)
    v_mfma_f32_16x16x32_bf16 v[156:159], v[212:215], v[52:55], v[156:159]
    ds_read_b128 a[12:15], v6 offset:2048
    ds_read_b128 v[184:187], v21 offset:16384
    v_mfma_f32_16x16x32_bf16 v[160:163], v[216:219], v[52:55], v[160:163]
    ds_read_b128 v[188:191], v21 offset:17408
    buffer_load_dwordx4 v13, s[12:15], s38 offen lds
    v_mfma_f32_16x16x32_bf16 v[164:167], v[220:223], v[52:55], v[164:167]
    ds_read_b128 v[200:203], v21 offset:18432
    ds_read_b128 a[28:31], v7 offset:2048
    s_waitcnt lgkmcnt(6)
    v_mfma_f32_16x16x32_bf16 v[144:147], v[168:171], v[56:59], v[144:147]
    ds_read_b128 v[204:207], v21 offset:19456
    buffer_load_dwordx4 v14, s[12:15], s38 offen offset:1024 lds
    s_add_u32 m0, s41, 49152
    s_add_u32 s57, s57, 98304
    s_cmp_eq_u32 s57, 983040
    s_cselect_b32 s57, 0, s57
    v_mfma_f32_16x16x32_bf16 v[148:151], v[172:175], v[56:59], v[148:151]
    ds_read_b128 v[208:211], v21 offset:20480
    buffer_load_dwordx4 v12, s[24:27], s57 offen sc1 lds
    v_mfma_f32_16x16x32_bf16 v[152:155], v[176:179], v[56:59], v[152:155]
    ds_read_b128 v[212:215], v21 offset:21504
    buffer_load_dwordx4 v12, s[24:27], s57 offen offset:1024 sc1 lds
    s_waitcnt lgkmcnt(5)
    v_mfma_f32_16x16x32_bf16 v[156:159], v[180:183], v[56:59], v[156:159]
    ds_read_b128 v[216:219], v21 offset:22528
    v_mfma_f32_16x16x32_bf16 v[160:163], v[184:187], v[56:59], v[160:163]
    buffer_load_dwordx4 v12, s[24:27], s57 offen offset:2048 sc1 lds
    s_add_u32 m0, s40, 0
    s_add_u32 s38, s83, s90
    ds_read_b128 v[220:223], v21 offset:23552
    v_mfma_f32_16x16x32_bf16 v[164:167], v[188:191], v[56:59], v[164:167]
    s_waitcnt vmcnt(8)
    s_mov_b32 s39, 0
L_h1_chk:
    v_cmp_ne_u32 vcc, s35, v233
    v_cmp_ne_u32 s[48:49], s35, v235
    s_or_b64 vcc, vcc, s[48:49]
    v_cmp_ne_u32 s[48:49], s35, v237
    s_or_b64 vcc, vcc, s[48:49]
    v_cmp_ne_u32 s[48:49], s35, v239
    s_or_b64 vcc, vcc, s[48:49]
    s_cbranch_scc0 L_h1_ok
    s_add_u32 s39, s39, 1
    s_cmp_lt_u32 s39, 400000
    s_cbranch_scc0 L_h1_ok
    buffer_load_dwordx4 v[232:235], v18, s[24:27], 0 offen sc1
    buffer_load_dwordx4 v[236:239], v18, s[24:27], 0 offen offset:1024 sc1
    s_waitcnt vmcnt(0)
    s_branch L_h1_chk
L_h1_ok:
    v_add_f32 v240, v232, v236
    v_add_f32 v241, v234, v238
    s_nop 0
    v_add_f32_dpp v240, v240, v240 row_ror:4 row_mask:0xf bank_mask:0xf
    v_add_f32_dpp v241, v241, v241 row_ror:4 row_mask:0xf bank_mask:0xf
    s_nop 0
    v_add_f32_dpp v240, v240, v240 row_ror:8 row_mask:0xf bank_mask:0xf
    v_add_f32_dpp v241, v241, v241 row_ror:8 row_mask:0xf bank_mask:0xf
    buffer_load_dwordx4 v13, s[12:15], s38 offen lds
    v_mul_f32 v240, 0x3aaaaaab, v240
    v_mul_f32 v241, 0x3aaaaaab, v241
    v_fma_f32 v241, -v240, v240, v241
    v_max_f32 v241, 0, v241
    v_add_f32 v241, 0x3727c5ac, v241
    v_rsq_f32 v241, v241
    s_nop 0
    v_mul_f32_e64 v240, -v240, v241
    v_mov_b32_dpp v244, v241 quad_perm:[0,0,0,0] row_mask:0xf bank_mask:0xf
    v_mov_b32_dpp v245, v241 quad_perm:[1,1,1,1] row_mask:0xf bank_mask:0xf
    v_mov_b32_dpp v246, v241 quad_perm:[2,2,2,2] row_mask:0xf bank_mask:0xf
    v_mov_b32_dpp v247, v241 quad_perm:[3,3,3,3] row_mask:0xf bank_mask:0xf
    v_mov_b32_dpp v248, v240 quad_perm:[0,0,0,0] row_mask:0xf bank_mask:0xf
    buffer_load_dwordx4 v14, s[12:15], s38 offen offset:1024 lds
    s_add_u32 m0, s40, 2048
    s_add_u32 s38, s83, s91
    v_mov_b32_dpp v249, v240 quad_perm:[1,1,1,1] row_mask:0xf bank_mask:0xf
    v_mov_b32_dpp v250, v240 quad_perm:[2,2,2,2] row_mask:0xf bank_mask:0xf
    v_mov_b32_dpp v251, v240 quad_perm:[3,3,3,3] row_mask:0xf bank_mask:0xf
    v_pk_fma_f32 v[112:113], v[112:113], v[244:245], v[248:249]
    v_pk_fma_f32 v[114:115], v[114:115], v[246:247], v[250:251]
    v_pk_fma_f32 v[116:117], v[116:117], v[244:245], v[248:249]
    v_pk_fma_f32 v[118:119], v[118:119], v[246:247], v[250:251]
    v_cvt_pk_bf16_f32 v112, v112, v113
    v_cvt_pk_bf16_f32 v113, v114, v115
    v_cvt_pk_bf16_f32 v114, v116, v117
    v_cvt_pk_bf16_f32 v115, v118, v119
    s_mov_b32 s36, 0
    v_permlane16_swap_b32 v112, v114
    s_waitcnt lgkmcnt(5)
    buffer_load_dwordx4 v13, s[12:15], s38 offen lds
    v_permlane16_swap_b32 v113, v115
    buffer_store_dwordx4 v[112:115], v19, s[24:27], s36 offen sc1
    v_pk_fma_f32 v[120:121], v[120:121], v[244:245], v[248:249]
    v_pk_fma_f32 v[122:123], v[122:123], v[246:247], v[250:251]
    v_pk_fma_f32 v[124:125], v[124:125], v[244:245], v[248:249]
    v_pk_fma_f32 v[126:127], v[126:127], v[246:247], v[250:251]
    v_cvt_pk_bf16_f32 v120, v120, v121
    v_cvt_pk_bf16_f32 v121, v122, v123
    v_cvt_pk_bf16_f32 v122, v124, v125
    buffer_load_dwordx4 v14, s[12:15], s38 offen offset:1024 lds
    s_add_u32 m0, s41, 0
    s_add_u32 s57, s57, 98304
    s_cmp_eq_u32 s57, 983040
    s_cselect_b32 s57, 0, s57
    v_cvt_pk_bf16_f32 v123, v126, v127
    s_mov_b32 s36, 131072
    v_permlane16_swap_b32 v120, v122
    v_permlane16_swap_b32 v121, v123
    buffer_store_dwordx4 v[120:123], v19, s[24:27], s36 offen sc1
    v_pk_fma_f32 v[128:129], v[128:129], v[244:245], v[248:249]
    v_pk_fma_f32 v[130:131], v[130:131], v[246:247], v[250:251]
    v_pk_fma_f32 v[132:133], v[132:133], v[244:245], v[248:249]
    v_pk_fma_f32 v[134:135], v[134:135], v[246:247], v[250:251]
    v_cvt_pk_bf16_f32 v128, v128, v129
    v_cvt_pk_bf16_f32 v129, v130, v131
    v_cvt_pk_bf16_f32 v130, v132, v133
    v_cvt_pk_bf16_f32 v131, v134, v135
    s_mov_b32 s36, 262144
    v_permlane16_swap_b32 v128, v130
    v_permlane16_swap_b32 v129, v131
    buffer_store_dwordx4 v[128:131], v19, s[24:27], s36 offen sc1
    v_pk_fma_f32 v[136:137], v[136:137], v[244:245], v[248:249]
    v_pk_fma_f32 v[138:139], v[138:139], v[246:247], v[250:251]
    v_pk_fma_f32 v[140:141], v[140:141], v[244:245], v[248:249]
    v_pk_fma_f32 v[142:143], v[142:143], v[246:247], v[250:251]
    v_cvt_pk_bf16_f32 v136, v136, v137
    v_cvt_pk_bf16_f32 v137, v138, v139
    v_cvt_pk_bf16_f32 v138, v140, v141
    v_cvt_pk_bf16_f32 v139, v142, v143
    s_mov_b32 s36, 393216
    v_permlane16_swap_b32 v136, v138
    v_permlane16_swap_b32 v137, v139
    buffer_store_dwordx4 v[136:139], v19, s[24:27], s36 offen sc1
    s_barrier
    buffer_load_dwordx4 v12, s[24:27], s57 offen sc1 lds
    ds_read_b128 v[168:171], v21 offset:24576
    buffer_load_dwordx4 v12, s[24:27], s57 offen offset:1024 sc1 lds
    s_waitcnt lgkmcnt(4)
    v_mfma_f32_16x16x32_bf16 v[144:147], v[200:203], v[60:63], v[144:147]
    ds_read_b128 v[172:175], v21 offset:25600
    buffer_load_dwordx4 v12, s[24:27], s57 offen offset:2048 sc1 lds
    s_add_u32 m0, s40, 4096
    s_add_u32 s38, s84, s88
    v_mfma_f32_16x16x32_bf16 v[148:151], v[204:207], v[60:63], v[148:151]
    ds_read_b128 a[32:35], v6 offset:4096
    ds_read_b128 v[176:179], v21 offset:26624
    v_mfma_f32_16x16x32_bf16 v[152:155], v[208:211], v[60:63], v[152:155]
    ds_read_b128 a[48:51], v7 offset:4096
    ds_read_b128 v[180:183], v21 offset:27648
    s_waitcnt lgkmcnt(6)
    v_mfma_f32_16x16x32_bf16 v[156:159], v[212:215], v[60:63], v[156:159]
    ds_read_b128 a[36:39], v6 offset:6144
    ds_read_b128 v[184:187], v21 offset:28672
    ds_read_b128 a[52:55], v7 offset:6144
    v_mfma_f32_16x16x32_bf16 v[160:163], v[216:219], v[60:63], v[160:163]
    ds_read_b128 v[188:191], v21 offset:29696
    ds_read_b128 a[40:43], v6 offset:8192
    v_mfma_f32_16x16x32_bf16 v[164:167], v[220:223], v[60:63], v[164:167]
    ds_read_b128 v[200:203], v21 offset:30720
    s_waitcnt lgkmcnt(7)
    buffer_load_dwordx4 v13, s[12:15], s38 offen lds
    v_mfma_f32_16x16x32_bf16 v[144:147], v[168:171], v[64:67], v[144:147]
    ds_read_b128 a[56:59], v7 offset:8192
    ds_read_b128 v[204:207], v21 offset:31744
    buffer_load_dwordx4 v14, s[12:15], s38 offen offset:1024 lds
    s_add_u32 m0, s40, 6144
    s_add_u32 s38, s84, s89
    v_mfma_f32_16x16x32_bf16 v[148:151], v[172:175], v[64:67], v[148:151]
    ds_read_b128 v[208:211], v21 offset:32768
    ds_read_b128 a[44:47], v6 offset:10240
    v_mfma_f32_16x16x32_bf16 v[152:155], v[176:179], v[64:67], v[152:155]
    ds_read_b128 v[212:215], v21 offset:33792
    s_waitcnt lgkmcnt(8)
    buffer_load_dwordx4 v13, s[12:15], s38 offen lds
    s_waitcnt lgkmcnt(7)
    v_mfma_f32_16x16x32_bf16 v[156:159], v[180:183], v[64:67], v[156:159]
    ds_read_b128 a[60:63], v7 offset:10240
    ds_read_b128 v[216:219], v21 offset:34816
    v_mfma_f32_16x16x32_bf16 v[160:163], v[184:187], v[64:67], v[160:163]
    buffer_load_dwordx4 v14, s[12:15], s38 offen offset:1024 lds
    s_add_u32 m0, s41, 12288
    s_add_u32 s57, s57, 98304
    s_cmp_eq_u32 s57, 983040
    s_cselect_b32 s57, 0, s57
    ds_read_b128 v[220:223], v21 offset:35840
    v_mfma_f32_16x16x32_bf16 v[164:167], v[188:191], v[64:67], v[164:167]
    s_waitcnt vmcnt(22)
    s_waitcnt vmcnt(7)
    s_barrier
    s_cmp_lg_u32 s32, 0
    s_cbranch_scc1 L_f2
    s_mov_b64 exec, 0xff
    buffer_store_dwordx4 v[28:31], v21, s[24:27], s96 offen sc1
    s_mov_b64 exec, -1
L_f2:
    buffer_load_dwordx4 v12, s[24:27], s57 offen sc1 lds
    ds_read_b128 v[168:171], v21 offset:36864
    s_waitcnt lgkmcnt(6)
    v_mfma_f32_16x16x32_bf16 v[144:147], v[200:203], v[68:71], v[144:147]
    buffer_load_dwordx4 v12, s[24:27], s57 offen offset:1024 sc1 lds
    ds_read_b128 v[172:175], v21 offset:37888
    v_mfma_f32_16x16x32_bf16 v[148:151], v[204:207], v[68:71], v[148:151]
    buffer_load_dwordx4 v12, s[24:27], s57 offen offset:2048 sc1 lds
    s_add_u32 m0, s40, 8192
    s_add_u32 s38, s84, s90
    ds_read_b128 v[176:179], v21 offset:38912
    v_mfma_f32_16x16x32_bf16 v[152:155], v[208:211], v[68:71], v[152:155]
    ds_read_b128 v[180:183], v21 offset:39936
    ds_read_b128 a[64:67], v6 offset:12288
    s_waitcnt lgkmcnt(5)
    v_mfma_f32_16x16x32_bf16 v[156:159], v[212:215], v[68:71], v[156:159]
    buffer_load_dwordx4 v13, s[12:15], s38 offen lds
    ds_read_b128 v[184:187], v21 offset:40960
L_page3:
    s_cbranch_execz L_ret0
    v_mfma_f32_16x16x32_bf16 v[160:163], v[216:219], v[68:71], v[160:163]
    ds_read_b128 v[188:191], v21 offset:41984
    ds_read_b128 a[80:83], v7 offset:12288
    v_mfma_f32_16x16x32_bf16 v[164:167], v[220:223], v[68:71], v[164:167]
    ds_read_b128 v[200:203], v21 offset:43008
    buffer_load_dwordx4 v14, s[12:15], s38 offen offset:1024 lds
    s_add_u32 m0, s40, 10240
    s_add_u32 s38, s84, s91
    s_waitcnt lgkmcnt(6)
    v_mfma_f32_16x16x32_bf16 v[144:147], v[168:171], v[72:75], v[144:147]
    ds_read_b128 v[204:207], v21 offset:44032
    ds_read_b128 a[68:71], v6 offset:14336
    v_mfma_f32_16x16x32_bf16 v[148:151], v[172:175], v[72:75], v[148:151]
    ds_read_b128 v[208:211], v21 offset:45056
    buffer_load_dwordx4 v13, s[12:15], s38 offen lds
    v_mfma_f32_16x16x32_bf16 v[152:155], v[176:179], v[72:75], v[152:155]
    ds_read_b128 v[212:215], v21 offset:46080
    ds_read_b128 a[84:87], v7 offset:14336
    s_waitcnt lgkmcnt(7)
    v_mfma_f32_16x16x32_bf16 v[156:159], v[180:183], v[72:75], v[156:159]
    ds_read_b128 v[216:219], v21 offset:47104
    v_mfma_f32_16x16x32_bf16 v[160:163], v[184:187], v[72:75], v[160:163]
    buffer_load_dwordx4 v14, s[12:15], s38 offen offset:1024 lds
    s_add_u32 m0, s41, 24576
    s_add_u32 s57, s57, 98304
    s_cmp_eq_u32 s57, 983040
    s_cselect_b32 s57, 0, s57
    ds_read_b128 v[220:223], v21 offset:48128
    v_mfma_f32_16x16x32_bf16 v[164:167], v[188:191], v[72:75], v[164:167]
    s_barrier
    buffer_load_dwordx4 v12, s[24:27], s57 offen sc1 lds
    ds_read_b128 v[168:171], v21 offset:49152
    s_waitcnt lgkmcnt(5)
    v_mfma_f32_16x16x32_bf16 v[144:147], v[200:203], v[76:79], v[144:147]
    buffer_load_dwordx4 v12, s[24:27], s57 offen offset:1024 sc1 lds
    ds_read_b128 v[172:175], v21 offset:50176
    v_mfma_f32_16x16x32_bf16 v[148:151], v[204:207], v[76:79], v[148:151]
    buffer_load_dwordx4 v12, s[24:27], s57 offen offset:2048 sc1 lds
    s_add_u32 m0, s40, 12288
    s_add_u32 s38, s85, s88
    ds_read_b128 v[176:179], v21 offset:51200
    v_mfma_f32_16x16x32_bf16 v[152:155], v[208:211], v[76:79], v[152:155]
    ds_read_b128 v[180:183], v21 offset:52224
    ds_read_b128 a[72:75], v6 offset:16384
    s_waitcnt lgkmcnt(5)
    v_mfma_f32_16x16x32_bf16 v[156:159], v[212:215], v[76:79], v[156:159]
    buffer_load_dwordx4 v13, s[12:15], s38 offen lds
    ds_read_b128 v[184:187], v21 offset:53248
    v_mfma_f32_16x16x32_bf16 v[160:163], v[216:219], v[76:79], v[160:163]
    ds_read_b128 v[188:191], v21 offset:54272
    ds_read_b128 a[88:91], v7 offset:16384
    v_mfma_f32_16x16x32_bf16 v[164:167], v[220:223], v[76:79], v[164:167]
    ds_read_b128 v[200:203], v21 offset:55296
    buffer_load_dwordx4 v14, s[12:15], s38 offen offset:1024 lds
    s_add_u32 m0, s40, 14336
    s_add_u32 s38, s85, s89
    s_waitcnt lgkmcnt(6)
    v_mfma_f32_16x16x32_bf16 v[144:147], v[168:171], v[80:83], v[144:147]
    ds_read_b128 v[204:207], v21 offset:56320
    ds_read_b128 a[76:79], v6 offset:18432
    v_mfma_f32_16x16x32_bf16 v[148:151], v[172:175], v[80:83], v[148:151]
    ds_read_b128 v[208:211], v21 offset:57344
    buffer_load_dwordx4 v13, s[12:15], s38 offen lds
    v_mfma_f32_16x16x32_bf16 v[152:155], v[176:179], v[80:83], v[152:155]
    ds_read_b128 v[212:215], v21 offset:58368
    ds_read_b128 a[92:95], v7 offset:18432
    s_waitcnt lgkmcnt(7)
    v_mfma_f32_16x16x32_bf16 v[156:159], v[180:183], v[80:83], v[156:159]
    ds_read_b128 v[216:219], v21 offset:59392
    v_mfma_f32_16x16x32_bf16 v[160:163], v[184:187], v[80:83], v[160:163]
    buffer_load_dwordx4 v14, s[12:15], s38 offen offset:1024 lds
    s_add_u32 m0, s40, 16384
    s_add_u32 s38, s85, s90
    ds_read_b128 v[220:223], v21 offset:60416
    v_mfma_f32_16x16x32_bf16 v[164:167], v[188:191], v[80:83], v[164:167]
    s_waitcnt vmcnt(18)
    s_barrier
    ds_read_b128 a[96:99], v6 offset:20480
    ds_read_b128 v[168:171], v21 offset:0
    s_waitcnt lgkmcnt(6)
    v_mfma_f32_16x16x32_bf16 v[144:147], v[200:203], v[84:87], v[144:147]
    buffer_load_dwordx4 v13, s[12:15], s38 offen lds
    ds_read_b128 v[172:175], v21 offset:1024
    v_mfma_f32_16x16x32_bf16 v[148:151], v[204:207], v[84:87], v[148:151]
    ds_read_b128 a[112:115], v7 offset:20480
    ds_read_b128 v[176:179], v21 offset:2048
    v_mfma_f32_16x16x32_bf16 v[152:155], v[208:211], v[84:87], v[152:155]
    buffer_load_dwordx4 v14, s[12:15], s38 offen offset:1024 lds
    s_add_u32 m0, s40, 18432
    s_add_u32 s38, s85, s91
    ds_read_b128 v[180:183], v21 offset:3072
    s_waitcnt lgkmcnt(6)
    v_mfma_f32_16x16x32_bf16 v[156:159], v[212:215], v[84:87], v[156:159]
    ds_read_b128 a[100:103], v6 offset:22528
    ds_read_b128 v[184:187], v21 offset:4096
    v_mfma_f32_16x16x32_bf16 v[160:163], v[216:219], v[84:87], v[160:163]
    buffer_load_dwordx4 v13, s[12:15], s38 offen lds
    ds_read_b128 v[188:191], v21 offset:5120
    v_mfma_f32_16x16x32_bf16 v[164:167], v[220:223], v[84:87], v[164:167]
    ds_read_b128 a[116:119], v7 offset:22528
    ds_read_b128 v[200:203], v21 offset:6144
    s_waitcnt lgkmcnt(6)
    v_mfma_f32_16x16x32_bf16 v[144:147], v[168:171], v[88:91], v[144:147]
    buffer_load_dwordx4 v14, s[12:15], s38 offen offset:1024 lds
    s_add_u32 m0, s40, 20480
    s_add_u32 s38, s86, s88
    ds_read_b128 v[204:207], v21 offset:7168
    v_mfma_f32_16x16x32_bf16 v[148:151], v[172:175], v[88:91], v[148:151]
    ds_read_b128 a[104:107], v6 offset:0
    ds_read_b128 v[208:211], v21 offset:8192
    v_mfma_f32_16x16x32_bf16 v[152:155], v[176:179], v[88:91], v[152:155]
    buffer_load_dwordx4 v13, s[12:15], s38 offen lds
    ds_read_b128 v[212:215], v21 offset:9216
    s_waitcnt lgkmcnt(6)
    v_mfma_f32_16x16x32_bf16 v[156:159], v[180:183], v[88:91], v[156:159]
    ds_read_b128 a[120:123], v7 offset:0
    ds_read_b128 v[216:219], v21 offset:10240
    v_mfma_f32_16x16x32_bf16 v[160:163], v[184:187], v[88:91], v[160:163]
    buffer_load_dwordx4 v14, s[12:15], s38 offen offset:1024 lds
    s_add_u32 m0, s40, 22528
    s_add_u32 s38, s86, s89
    ds_read_b128 v[220:223], v21 offset:11264
    v_mfma_f32_16x16x32_bf16 v[164:167], v[188:191], v[88:91], v[164:167]
    s_waitcnt vmcnt(17)
    s_barrier
    ds_read_b128 a[108:111], v6 offset:2048
    ds_read_b128 v[168:171], v21 offset:12288
    s_waitcnt lgkmcnt(6)
    v_mfma_f32_16x16x32_bf16 v[144:147], v[200:203], v[92:95], v[144:147]
    buffer_load_dwordx4 v13, s[12:15], s38 offen lds
    ds_read_b128 v[172:175], v21 offset:13312
    v_mfma_f32_16x16x32_bf16 v[148:151], v[204:207], v[92:95], v[148:151]
    ds_read_b128 a[124:127], v7 offset:2048
    ds_read_b128 v[176:179], v21 offset:14336
    v_mfma_f32_16x16x32_bf16 v[152:155], v[208:211], v[92:95], v[152:155]
    buffer_load_dwordx4 v14, s[12:15], s38 offen offset:1024 lds
    s_add_u32 m0, s40, 0
    s_add_u32 s38, s86, s90
    ds_read_b128 v[180:183], v21 offset:15360
    s_waitcnt lgkmcnt(6)
    v_mfma_f32_16x16x32_bf16 v[156:159], v[212:215], v[92:95], v[156:159]
    ds_read_b128 a[128:131], v6 offset:4096
    ds_read_b128 v[184:187], v21 offset:16384
    v_mfma_f32_16x16x32_bf16 v[160:163], v[216:219], v[92:95], v[160:163]
    buffer_load_dwordx4 v13, s[12:15], s38 offen lds
    ds_read_b128 v[188:191], v21 offset:17408
    v_mfma_f32_16x16x32_bf16 v[164:167], v[220:223], v[92:95], v[164:167]
    ds_read_b128 a[144:147], v7 offset:4096
    ds_read_b128 v[200:203], v21 offset:18432
    s_waitcnt lgkmcnt(6)
    v_mfma_f32_16x16x32_bf16 v[144:147], v[168:171], v[96:99], v[144:147]
    buffer_load_dwordx4 v14, s[12:15], s38 offen offset:1024 lds
    s_add_u32 m0, s40, 2048
    s_add_u32 s38, s86, s91
    ds_read_b128 v[204:207], v21 offset:19456
    v_mfma_f32_16x16x32_bf16 v[148:151], v[172:175], v[96:99], v[148:151]
    ds_read_b128 a[132:135], v6 offset:6144
    ds_read_b128 v[208:211], v21 offset:20480
    v_mfma_f32_16x16x32_bf16 v[152:155], v[176:179], v[96:99], v[152:155]
    buffer_load_dwordx4 v13, s[12:15], s38 offen lds
    ds_read_b128 v[212:215], v21 offset:21504
    s_waitcnt lgkmcnt(6)
    v_mfma_f32_16x16x32_bf16 v[156:159], v[180:183], v[96:99], v[156:159]
    ds_read_b128 a[148:151], v7 offset:6144
    ds_read_b128 v[216:219], v21 offset:22528
    v_mfma_f32_16x16x32_bf16 v[160:163], v[184:187], v[96:99], v[160:163]
    buffer_load_dwordx4 v14, s[12:15], s38 offen offset:1024 lds
    s_add_u32 m0, s40, 4096
    s_add_u32 s38, s87, s88
    ds_read_b128 v[220:223], v21 offset:23552
    v_mfma_f32_16x16x32_bf16 v[164:167], v[188:191], v[96:99], v[164:167]
    s_waitcnt vmcnt(16)
    s_barrier
    ds_read_b128 a[136:139], v6 offset:8192
    buffer_load_dword v17, v22, s[24:27], s97 offen sc1
    ds_read_b128 v[168:171], v21 offset:24576
    s_waitcnt lgkmcnt(10)
    buffer_load_dwordx4 v13, s[12:15], s38 offen lds
    s_waitcnt lgkmcnt(6)
    v_mfma_f32_16x16x32_bf16 v[144:147], v[200:203], v[100:103], v[144:147]
    ds_read_b128 v[172:175], v21 offset:25600
    ds_read_b128 a[152:155], v7 offset:8192
    v_mfma_f32_16x16x32_bf16 v[148:151], v[204:207], v[100:103], v[148:151]
    ds_read_b128 v[176:179], v21 offset:26624
    buffer_load_dwordx4 v14, s[12:15], s38 offen offset:1024 lds
    s_add_u32 m0, s40, 6144
    s_add_u32 s38, s87, s89
    v_mfma_f32_16x16x32_bf16 v[152:155], v[208:211], v[100:103], v[152:155]
    ds_read_b128 v[180:183], v21 offset:27648
    ds_read_b128 a[140:143], v6 offset:10240
    s_waitcnt lgkmcnt(7)
    v_mfma_f32_16x16x32_bf16 v[156:159], v[212:215], v[100:103], v[156:159]
    buffer_load_dwordx4 v13, s[12:15], s38 offen lds
    ds_read_b128 v[184:187], v21 offset:28672
    v_mfma_f32_16x16x32_bf16 v[160:163], v[216:219], v[100:103], v[160:163]
    ds_read_b128 a[156:159], v7 offset:10240
    ds_read_b128 v[188:191], v21 offset:29696
    v_mfma_f32_16x16x32_bf16 v[164:167], v[220:223], v[100:103], v[164:167]
    ds_read_b128 v[200:203], v21 offset:30720
    buffer_load_dwordx4 v14, s[12:15], s38 offen offset:1024 lds
    s_add_u32 m0, s40, 8192
    s_add_u32 s38, s87, s90
    s_waitcnt lgkmcnt(6)
    v_mfma_f32_16x16x32_bf16 v[144:147], v[168:171], v[104:107], v[144:147]
    s_waitcnt vmcnt(19)
    ds_read_b128 a[160:163], v6 offset:12288
    ds_read_b128 v[204:207], v21 offset:31744
    v_mfma_f32_16x16x32_bf16 v[148:151], v[172:175], v[104:107], v[148:151]
    buffer_load_dwordx4 v13, s[12:15], s38 offen lds
    ds_read_b128 v[208:211], v21 offset:32768
    v_mfma_f32_16x16x32_bf16 v[152:155], v[176:179], v[104:107], v[152:155]
    ds_read_b128 a[176:179], v7 offset:12288
    ds_read_b128 v[212:215], v21 offset:33792
    s_waitcnt lgkmcnt(6)
    v_mfma_f32_16x16x32_bf16 v[156:159], v[180:183], v[104:107], v[156:159]
    buffer_load_dwordx4 v14, s[12:15], s38 offen offset:1024 lds
    s_add_u32 m0, s40, 10240
    s_add_u32 s38, s87, s91
    ds_read_b128 v[216:219], v21 offset:34816
    s_waitcnt vmcnt(19)
    ds_read_b128 a[164:167], v6 offset:14336
    v_mfma_f32_16x16x32_bf16 v[160:163], v[184:187], v[104:107], v[160:163]
    ds_read_b128 v[220:223], v21 offset:35840
    buffer_load_dwordx4 v13, s[12:15], s38 offen lds
    v_mfma_f32_16x16x32_bf16 v[164:167], v[188:191], v[104:107], v[164:167]
    s_waitcnt lgkmcnt(6)
    v_mfma_f32_16x16x32_bf16 v[144:147], v[200:203], v[108:111], v[144:147]
    ds_read_b128 a[180:183], v7 offset:14336
    v_mfma_f32_16x16x32_bf16 v[148:151], v[204:207], v[108:111], v[148:151]
    s_waitcnt lgkmcnt(4)
    v_mfma_f32_16x16x32_bf16 v[152:155], v[208:211], v[108:111], v[152:155]
    v_mfma_f32_16x16x32_bf16 v[156:159], v[212:215], v[108:111], v[156:159]
    buffer_load_dwordx4 v14, s[12:15], s38 offen offset:1024 lds
    s_waitcnt lgkmcnt(1)
    v_mfma_f32_16x16x32_bf16 v[160:163], v[216:219], v[108:111], v[160:163]
    v_mfma_f32_16x16x32_bf16 v[164:167], v[220:223], v[108:111], v[164:167]
    s_waitcnt vmcnt(8)
    s_mov_b32 s39, 0
L_h2_chk:
    v_cmp_ne_u32 vcc, s35, v17
    s_cmp_lg_u64 vcc, 0
    s_cbranch_scc0 L_h2_ok
    s_add_u32 s39, s39, 1
    s_cmp_lt_u32 s39, 400000
    s_cbranch_scc0 L_h2_ok
    buffer_load_dword v17, v22, s[24:27], s97 offen sc1
    s_waitcnt vmcnt(0)
    s_branch L_h2_chk
L_h2_ok:
    v_lshlrev_b32 v128, 16, v16
    v_lshlrev_b32 v129, 16, v16
    v_lshlrev_b32 v130, 16, v16
    v_lshlrev_b32 v131, 16, v16
    ds_read_b128 a[168:171], v6 offset:16384
    buffer_load_dwordx4 v[32:35], v20, s[24:27], s72 offen sc1
    ds_read_b128 a[184:187], v7 offset:16384
    buffer_load_dwordx4 v[36:39], v20, s[24:27], s72 offen offset:1024 sc1
    ds_read_b128 a[172:175], v6 offset:18432
    ds_read_b128 a[188:191], v7 offset:18432
    buffer_load_dwordx4 v[40:43], v20, s[24:27], s73 offen sc1
    ds_read_b128 a[192:195], v6 offset:20480
    ds_read_b128 a[208:211], v7 offset:20480
    buffer_load_dwordx4 v[44:47], v20, s[24:27], s73 offen offset:1024 sc1
    ds_read_b128 a[196:199], v6 offset:22528
    ds_read_b128 a[212:215], v7 offset:22528
    buffer_load_dwordx4 v[48:51], v20, s[24:27], s74 offen sc1
    ds_read_b128 a[200:203], v6 offset:0
    buffer_load_dwordx4 v[52:55], v20, s[24:27], s74 offen offset:1024 sc1
    ds_read_b128 a[216:219], v7 offset:0
    ds_read_b128 a[204:207], v6 offset:2048
    buffer_load_dwordx4 v[56:59], v20, s[24:27], s75 offen sc1
    ds_read_b128 a[220:223], v7 offset:2048
    buffer_load_dwordx4 v[60:63], v20, s[24:27], s75 offen offset:1024 sc1
    s_waitcnt vmcnt(14)
    ds_read_b128 a[224:227], v6 offset:4096
    ds_read_b128 a[240:243], v7 offset:4096
    buffer_load_dwordx4 v[64:67], v20, s[24:27], s76 offen sc1
    s_waitcnt vmcnt(13)
    ds_read_b128 a[228:231], v6 offset:6144
    ds_read_b128 a[244:247], v7 offset:6144
    buffer_load_dwordx4 v[68:71], v20, s[24:27], s76 offen offset:1024 sc1
    s_waitcnt vmcnt(12)
    ds_read_b128 a[232:235], v6 offset:8192
    ds_read_b128 a[248:251], v7 offset:8192
    buffer_load_dwordx4 v[72:75], v20, s[24:27], s77 offen sc1
    s_waitcnt vmcnt(11)
    ds_read_b128 a[236:239], v6 offset:10240
    buffer_load_dwordx4 v[76:79], v20, s[24:27], s77 offen offset:1024 sc1
    ds_read_b128 a[252:255], v7 offset:10240
L_join:
    s_waitcnt vmcnt(10)
    v_mfma_f32_16x16x32_bf16 v[168:171], v[32:35], a[0:3], v[128:131]
    s_mul_i32 s54, s34, 160
    v_mfma_f32_16x16x32_bf16 v[168:171], v[36:39], a[16:19], v[168:171]
    buffer_load_dwordx4 v[80:83], v20, s[24:27], s78 offen sc1
    v_mfma_f32_16x16x32_bf16 v[172:175], v[32:35], a[4:7], 0
    s_mul_i32 s56, s32, 3584
    v_mul_f32 v132, v144, v144
    v_mul_f32 v133, v145, v145
    v_mfma_f32_16x16x32_bf16 v[172:175], v[36:39], a[20:23], v[172:175]
    v_mfma_f32_16x16x32_bf16 v[176:179], v[32:35], a[8:11], 0
    v_mfma_f32_16x16x32_bf16 v[176:179], v[36:39], a[24:27], v[176:179]
    buffer_load_dwordx4 v[84:87], v20, s[24:27], s78 offen offset:1024 sc1
    v_mfma_f32_16x16x32_bf16 v[180:183], v[32:35], a[12:15], 0
    s_add_u32 s56, s56, 147456
    v_mul_f32 v134, v146, v146
    v_mul_f32 v135, v147, v147
    v_mfma_f32_16x16x32_bf16 v[180:183], v[36:39], a[28:31], v[180:183]
    s_waitcnt vmcnt(10)
    v_mfma_f32_16x16x32_bf16 v[168:171], v[40:43], a[32:35], v[168:171]
    v_fma_f32 v132, v132, s46, v2
    v_fma_f32 v133, v133, s46, v2
    v_mfma_f32_16x16x32_bf16 v[168:171], v[44:47], a[48:51], v[168:171]
    buffer_load_dwordx4 v[32:35], v20, s[24:27], s79 offen sc1
    v_mfma_f32_16x16x32_bf16 v[172:175], v[40:43], a[36:39], v[172:175]
    v_mul_u32_u24 v233, 205, v0
    v_lshrrev_b32 v233, 11, v233
    v_mfma_f32_16x16x32_bf16 v[172:175], v[44:47], a[52:55], v[172:175]
    v_fma_f32 v134, v134, s46, v2
    v_fma_f32 v135, v135, s46, v2
    v_mfma_f32_16x16x32_bf16 v[176:179], v[40:43], a[40:43], v[176:179]
    v_mad_i32_i24 v232, v233, -10, v0
    v_mad_u32_u24 v12, v233, 11, v232
    v_mfma_f32_16x16x32_bf16 v[176:179], v[44:47], a[56:59], v[176:179]
    buffer_load_dwordx4 v[36:39], v20, s[24:27], s79 offen offset:1024 sc1
    v_mfma_f32_16x16x32_bf16 v[180:183], v[40:43], a[44:47], v[180:183]
    v_mul_f32 v132, v132, v144
    v_mul_f32 v133, v133, v145
    v_mfma_f32_16x16x32_bf16 v[180:183], v[44:47], a[60:63], v[180:183]
    s_waitcnt vmcnt(10)
    v_lshl_add_u32 v12, v12, 4, s56
    v_mul_u32_u24 v233, 1280, v233
    v_mfma_f32_16x16x32_bf16 v[168:171], v[48:51], a[64:67], v[168:171]
    v_add_u32 v20, 0x10000, v20
    v_mfma_f32_16x16x32_bf16 v[168:171], v[52:55], a[80:83], v[168:171]
    buffer_load_dwordx4 v[40:43], v20, s[24:27], s72 offen sc1
    v_mfma_f32_16x16x32_bf16 v[172:175], v[48:51], a[68:71], v[172:175]
    v_mul_f32 v134, v134, v146
    v_mul_f32 v135, v135, v147
    v_mfma_f32_16x16x32_bf16 v[172:175], v[52:55], a[84:87], v[172:175]
    v_lshl_add_u32 v4, v232, 4, v233
    v_add_u32 v232, 64, v0
    v_mfma_f32_16x16x32_bf16 v[176:179], v[48:51], a[72:75], v[176:179]
    v_exp_f32 v132, v132
    v_mfma_f32_16x16x32_bf16 v[176:179], v[52:55], a[88:91], v[176:179]
    buffer_load_dwordx4 v[44:47], v20, s[24:27], s72 offen offset:1024 sc1
    v_mfma_f32_16x16x32_bf16 v[180:183], v[48:51], a[76:79], v[180:183]
    v_mul_u32_u24 v233, 205, v232
    v_lshrrev_b32 v233, 11, v233
    v_mfma_f32_16x16x32_bf16 v[180:183], v[52:55], a[92:95], v[180:183]
    s_waitcnt vmcnt(10)
    v_exp_f32 v133, v133
    v_mfma_f32_16x16x32_bf16 v[168:171], v[56:59], a[96:99], v[168:171]
    v_mad_i32_i24 v232, v233, -10, v232
    v_mad_u32_u24 v13, v233, 11, v232
    v_mfma_f32_16x16x32_bf16 v[168:171], v[60:63], a[112:115], v[168:171]
    buffer_load_dwordx4 v[48:51], v20, s[24:27], s73 offen sc1
    v_mfma_f32_16x16x32_bf16 v[172:175], v[56:59], a[100:103], v[172:175]
    v_lshl_add_u32 v13, v13, 4, s56
    v_mul_u32_u24 v233, 1280, v233
    v_mfma_f32_16x16x32_bf16 v[172:175], v[60:63], a[116:119], v[172:175]
    v_exp_f32 v134, v134
    v_mfma_f32_16x16x32_bf16 v[176:179], v[56:59], a[104:107], v[176:179]
    v_lshl_add_u32 v5, v232, 4, v233
    v_add_u32 v232, 128, v0
    v_mfma_f32_16x16x32_bf16 v[176:179], v[60:63], a[120:123], v[176:179]
    buffer_load_dwordx4 v[52:55], v20, s[24:27], s73 offen offset:1024 sc1
    v_mfma_f32_16x16x32_bf16 v[180:183], v[56:59], a[108:111], v[180:183]
    v_exp_f32 v135, v135
    v_mfma_f32_16x16x32_bf16 v[180:183], v[60:63], a[124:127], v[180:183]
    s_waitcnt vmcnt(10)
    v_mul_u32_u24 v233, 205, v232
    v_lshrrev_b32 v233, 11, v233
    v_mfma_f32_16x16x32_bf16 v[168:171], v[64:67], a[128:131], v[168:171]
    v_add_f32 v132, 1.0, v132
    v_add_f32 v133, 1.0, v133
    v_mfma_f32_16x16x32_bf16 v[168:171], v[68:71], a[144:147], v[168:171]
    buffer_load_dwordx4 v[56:59], v20, s[24:27], s74 offen sc1
    v_mfma_f32_16x16x32_bf16 v[172:175], v[64:67], a[132:135], v[172:175]
    v_mad_i32_i24 v232, v233, -10, v232
    v_mad_u32_u24 v14, v233, 11, v232
    v_mfma_f32_16x16x32_bf16 v[172:175], v[68:71], a[148:151], v[172:175]
    v_add_f32 v134, 1.0, v134
    v_add_f32 v135, 1.0, v135
    v_mfma_f32_16x16x32_bf16 v[176:179], v[64:67], a[136:139], v[176:179]
    v_mfma_f32_16x16x32_bf16 v[176:179], v[68:71], a[152:155], v[176:179]
    buffer_load_dwordx4 v[60:63], v20, s[24:27], s74 offen offset:1024 sc1
    v_mfma_f32_16x16x32_bf16 v[180:183], v[64:67], a[140:143], v[180:183]
    v_lshl_add_u32 v14, v14, 4, s56
    v_mul_u32_u24 v233, 1280, v233
    v_mfma_f32_16x16x32_bf16 v[180:183], v[68:71], a[156:159], v[180:183]
    s_waitcnt vmcnt(10) lgkmcnt(15)
    v_rcp_f32 v132, v132
    v_mfma_f32_16x16x32_bf16 v[168:171], v[72:75], a[160:163], v[168:171]
    v_lshl_add_u32 v6, v232, 4, v233
    v_add_u32 v9, 61440, v21
    v_mfma_f32_16x16x32_bf16 v[168:171], v[76:79], a[176:179], v[168:171]
    buffer_load_dwordx4 v[64:67], v20, s[24:27], s75 offen sc1
    v_mfma_f32_16x16x32_bf16 v[172:175], v[72:75], a[164:167], v[172:175]
    v_rcp_f32 v133, v133
    v_mfma_f32_16x16x32_bf16 v[172:175], v[76:79], a[180:183], v[172:175]
    v_and_b32 v232, 15, v0
    v_mul_u32_u24 v232, 176, v232
    v_mfma_f32_16x16x32_bf16 v[176:179], v[72:75], a[168:171], v[176:179]
    v_rcp_f32 v134, v134
    v_mfma_f32_16x16x32_bf16 v[176:179], v[76:79], a[184:187], v[176:179]
    buffer_load_dwordx4 v[68:71], v20, s[24:27], s75 offen offset:1024 sc1
    v_mfma_f32_16x16x32_bf16 v[180:183], v[72:75], a[172:175], v[180:183]
    v_lshrrev_b32 v233, 4, v0
    v_lshl_add_u32 v232, v233, 3, v232
    v_mfma_f32_16x16x32_bf16 v[180:183], v[76:79], a[188:191], v[180:183]
    s_waitcnt vmcnt(10) lgkmcnt(8)
    v_rcp_f32 v135, v135
    v_mfma_f32_16x16x32_bf16 v[168:171], v[80:83], a[192:195], v[168:171]
    v_mfma_f32_16x16x32_bf16 v[168:171], v[84:87], a[208:211], v[168:171]
    buffer_load_dwordx4 v[72:75], v20, s[24:27], s76 offen sc1
    v_mfma_f32_16x16x32_bf16 v[172:175], v[80:83], a[196:199], v[172:175]
    v_add_u32 v11, s56, v232
    v_mfma_f32_16x16x32_bf16 v[172:175], v[84:87], a[212:215], v[172:175]
    s_mul_i32 s69, s101, 20480
    v_mul_f32 v144, v144, v132
    v_mul_f32 v145, v145, v133
    v_mfma_f32_16x16x32_bf16 v[176:179], v[80:83], a[200:203], v[176:179]
    v_mfma_f32_16x16x32_bf16 v[176:179], v[84:87], a[216:219], v[176:179]
    buffer_load_dwordx4 v[76:79], v20, s[24:27], s76 offen offset:1024 sc1
    v_mfma_f32_16x16x32_bf16 v[180:183], v[80:83], a[204:207], v[180:183]
    s_add_u32 s69, s69, s54
    v_mul_f32 v146, v146, v134
    v_mul_f32 v147, v147, v135
    v_mfma_f32_16x16x32_bf16 v[180:183], v[84:87], a[220:223], v[180:183]
    s_waitcnt vmcnt(10) lgkmcnt(0)
    v_mfma_f32_16x16x32_bf16 v[168:171], v[32:35], a[224:227], v[168:171]
    v_mfma_f32_16x16x32_bf16 v[168:171], v[36:39], a[240:243], v[168:171]
    buffer_load_dwordx4 v[80:83], v20, s[24:27], s77 offen sc1
    v_mfma_f32_16x16x32_bf16 v[172:175], v[32:35], a[228:231], v[172:175]
    s_mul_i32 s56, s101, 24576
    v_mfma_f32_16x16x32_bf16 v[172:175], v[36:39], a[244:247], v[172:175]
    v_mfma_f32_16x16x32_bf16 v[176:179], v[32:35], a[232:235], v[176:179]
    s_barrier
    s_add_u32 s56, s56, 4194304
    v_mfma_f32_16x16x32_bf16 v[176:179], v[36:39], a[248:251], v[176:179]
    buffer_load_dwordx4 v[84:87], v20, s[24:27], s77 offen offset:1024 sc1
    v_mfma_f32_16x16x32_bf16 v[180:183], v[32:35], a[236:239], v[180:183]
    v_mfma_f32_16x16x32_bf16 v[180:183], v[36:39], a[252:255], v[180:183]
    s_waitcnt vmcnt(10)
    s_add_u32 s55, s34, 1
    v_mfma_f32_16x16x32_bf16 v[184:187], v[40:43], a[0:3], v[128:131]
    v_mul_f32 v132, v148, v148
    v_mul_f32 v133, v149, v149
    v_mfma_f32_16x16x32_bf16 v[184:187], v[44:47], a[16:19], v[184:187]
    buffer_load_dwordx4 v[32:35], v20, s[24:27], s78 offen sc1
    v_mfma_f32_16x16x32_bf16 v[188:191], v[40:43], a[4:7], 0
    s_and_b32 s55, s55, 7
    v_mul_f32 v134, v150, v150
    v_mul_f32 v135, v151, v151
    v_mfma_f32_16x16x32_bf16 v[188:191], v[44:47], a[20:23], v[188:191]
    v_mfma_f32_16x16x32_bf16 v[192:195], v[40:43], a[8:11], 0
    v_mfma_f32_16x16x32_bf16 v[192:195], v[44:47], a[24:27], v[192:195]
    buffer_load_dwordx4 v[36:39], v20, s[24:27], s78 offen offset:1024 sc1
    v_mfma_f32_16x16x32_bf16 v[196:199], v[40:43], a[12:15], 0
    s_mul_i32 s55, s55, 3072
    v_fma_f32 v132, v132, s46, v2
    v_fma_f32 v133, v133, s46, v2
    v_mfma_f32_16x16x32_bf16 v[196:199], v[44:47], a[28:31], v[196:199]
    s_waitcnt vmcnt(10)
    v_mfma_f32_16x16x32_bf16 v[184:187], v[48:51], a[32:35], v[184:187]
    ds_write_b128 v23, v[172:175] offset:0
    v_mfma_f32_16x16x32_bf16 v[184:187], v[52:55], a[48:51], v[184:187]
    buffer_load_dwordx4 v[40:43], v20, s[24:27], s79 offen sc1
    v_mfma_f32_16x16x32_bf16 v[188:191], v[48:51], a[36:39], v[188:191]
    s_add_u32 s59, s55, s56
    v_fma_f32 v134, v134, s46, v2
    v_fma_f32 v135, v135, s46, v2
    v_mfma_f32_16x16x32_bf16 v[188:191], v[52:55], a[52:55], v[188:191]
    ds_write_b128 v24, v[176:179] offset:0
    v_mfma_f32_16x16x32_bf16 v[192:195], v[48:51], a[40:43], v[192:195]
    s_add_u32 s55, s34, 2
    v_mul_f32 v132, v132, v148
    v_mul_f32 v133, v133, v149
    v_mfma_f32_16x16x32_bf16 v[192:195], v[52:55], a[56:59], v[192:195]
    buffer_load_dwordx4 v[44:47], v20, s[24:27], s79 offen offset:1024 sc1
    v_mfma_f32_16x16x32_bf16 v[196:199], v[48:51], a[44:47], v[196:199]
    ds_write_b128 v25, v[180:183] offset:0
    v_mfma_f32_16x16x32_bf16 v[196:199], v[52:55], a[60:63], v[196:199]
    s_waitcnt vmcnt(10)
    v_mul_f32 v134, v134, v150
    v_mul_f32 v135, v135, v151
    v_mfma_f32_16x16x32_bf16 v[184:187], v[56:59], a[64:67], v[184:187]
    v_add_u32 v20, 0x10000, v20
    s_and_b32 s55, s55, 7
    v_mfma_f32_16x16x32_bf16 v[184:187], v[60:63], a[80:83], v[184:187]
    buffer_load_dwordx4 v[48:51], v20, s[24:27], s72 offen sc1
    v_mfma_f32_16x16x32_bf16 v[188:191], v[56:59], a[68:71], v[188:191]
    s_mul_i32 s55, s55, 3072
    v_exp_f32 v132, v132
    v_mfma_f32_16x16x32_bf16 v[188:191], v[60:63], a[84:87], v[188:191]
    s_add_u32 s60, s55, s56
    v_exp_f32 v133, v133
    v_mfma_f32_16x16x32_bf16 v[192:195], v[56:59], a[72:75], v[192:195]
    v_mfma_f32_16x16x32_bf16 v[192:195], v[60:63], a[88:91], v[192:195]
    buffer_load_dwordx4 v[52:55], v20, s[24:27], s72 offen offset:1024 sc1
    v_mfma_f32_16x16x32_bf16 v[196:199], v[56:59], a[76:79], v[196:199]
    s_waitcnt lgkmcnt(0)
    s_barrier
    s_add_u32 s55, s34, 3
    v_mfma_f32_16x16x32_bf16 v[196:199], v[60:63], a[92:95], v[196:199]
    s_waitcnt vmcnt(10)
    v_exp_f32 v134, v134
    v_mfma_f32_16x16x32_bf16 v[184:187], v[64:67], a[96:99], v[184:187]
    ds_read_b128 v[200:203], v26 offset:0
    v_mfma_f32_16x16x32_bf16 v[184:187], v[68:71], a[112:115], v[184:187]
    buffer_load_dwordx4 v[56:59], v20, s[24:27], s73 offen sc1
    v_mfma_f32_16x16x32_bf16 v[188:191], v[64:67], a[100:103], v[188:191]
    s_and_b32 s55, s55, 7
    v_exp_f32 v135, v135
    v_mfma_f32_16x16x32_bf16 v[188:191], v[68:71], a[116:119], v[188:191]
    ds_read_b128 v[204:207], v26 offset:1024
    v_mfma_f32_16x16x32_bf16 v[192:195], v[64:67], a[104:107], v[192:195]
    ds_read_b128 v[208:211], v26 offset:2048
    s_mul_i32 s55, s55, 3072
    v_mfma_f32_16x16x32_bf16 v[192:195], v[68:71], a[120:123], v[192:195]
    buffer_load_dwordx4 v[60:63], v20, s[24:27], s73 offen offset:1024 sc1
    v_mfma_f32_16x16x32_bf16 v[196:199], v[64:67], a[108:111], v[196:199]
    v_add_f32 v132, 1.0, v132
    v_add_f32 v133, 1.0, v133
    v_mfma_f32_16x16x32_bf16 v[196:199], v[68:71], a[124:127], v[196:199]
    s_waitcnt vmcnt(10)
    v_add_f32 v134, 1.0, v134
    v_add_f32 v135, 1.0, v135
    v_mfma_f32_16x16x32_bf16 v[184:187], v[72:75], a[128:131], v[184:187]
    s_add_u32 s61, s55, s56
    v_mfma_f32_16x16x32_bf16 v[184:187], v[76:79], a[144:147], v[184:187]
    buffer_load_dwordx4 v[64:67], v20, s[24:27], s74 offen sc1
    v_mfma_f32_16x16x32_bf16 v[188:191], v[72:75], a[132:135], v[188:191]
    s_add_u32 s55, s34, 4
    v_rcp_f32 v132, v132
    v_mfma_f32_16x16x32_bf16 v[188:191], v[76:79], a[148:151], v[188:191]
    v_mfma_f32_16x16x32_bf16 v[192:195], v[72:75], a[136:139], v[192:195]
    v_rcp_f32 v133, v133
    v_mfma_f32_16x16x32_bf16 v[192:195], v[76:79], a[152:155], v[192:195]
    buffer_load_dwordx4 v[68:71], v20, s[24:27], s74 offen offset:1024 sc1
    v_mfma_f32_16x16x32_bf16 v[196:199], v[72:75], a[140:143], v[196:199]
    s_and_b32 s55, s55, 7
    s_waitcnt lgkmcnt(0)
    v_add_f32 v168, v168, v200
    v_mfma_f32_16x16x32_bf16 v[196:199], v[76:79], a[156:159], v[196:199]
    s_waitcnt vmcnt(10)
    v_rcp_f32 v134, v134
    v_mfma_f32_16x16x32_bf16 v[184:187], v[80:83], a[160:163], v[184:187]
    s_mul_i32 s55, s55, 3072
    v_add_f32 v169, v169, v201
    v_add_f32 v170, v170, v202
    v_mfma_f32_16x16x32_bf16 v[184:187], v[84:87], a[176:179], v[184:187]
    buffer_load_dwordx4 v[72:75], v20, s[24:27], s75 offen sc1
    v_mfma_f32_16x16x32_bf16 v[188:191], v[80:83], a[164:167], v[188:191]
    s_add_u32 s62, s55, s56
    v_rcp_f32 v135, v135
    v_mfma_f32_16x16x32_bf16 v[188:191], v[84:87], a[180:183], v[188:191]
    v_add_f32 v171, v171, v203
    v_add_f32 v168, v168, v204
    v_mfma_f32_16x16x32_bf16 v[192:195], v[80:83], a[168:171], v[192:195]
    v_mul_f32 v148, v148, v132
    v_mul_f32 v149, v149, v133
    v_mfma_f32_16x16x32_bf16 v[192:195], v[84:87], a[184:187], v[192:195]
    buffer_load_dwordx4 v[76:79], v20, s[24:27], s75 offen offset:1024 sc1
    v_mfma_f32_16x16x32_bf16 v[196:199], v[80:83], a[172:175], v[196:199]
    s_add_u32 s55, s34, 5
    v_add_f32 v169, v169, v205
    v_add_f32 v170, v170, v206
    v_mfma_f32_16x16x32_bf16 v[196:199], v[84:87], a[188:191], v[196:199]
    s_waitcnt vmcnt(10)
    v_add_f32 v171, v171, v207
    v_add_f32 v168, v168, v208
    v_mfma_f32_16x16x32_bf16 v[184:187], v[32:35], a[192:195], v[184:187]
    s_and_b32 s55, s55, 7
    v_mul_f32 v150, v150, v134
    v_mul_f32 v151, v151, v135
    v_mfma_f32_16x16x32_bf16 v[184:187], v[36:39], a[208:211], v[184:187]
    buffer_load_dwordx4 v[80:83], v20, s[24:27], s76 offen sc1
    v_mfma_f32_16x16x32_bf16 v[188:191], v[32:35], a[196:199], v[188:191]
    v_add_f32 v169, v169, v209
    v_add_f32 v170, v170, v210
    v_mfma_f32_16x16x32_bf16 v[188:191], v[36:39], a[212:215], v[188:191]
    s_mul_i32 s55, s55, 3072
    v_add_f32 v171, v171, v211
    v_mul_f32 v168, v168, v144
    v_mfma_f32_16x16x32_bf16 v[192:195], v[32:35], a[200:203], v[192:195]
    v_mfma_f32_16x16x32_bf16 v[192:195], v[36:39], a[216:219], v[192:195]
    buffer_load_dwordx4 v[84:87], v20, s[24:27], s76 offen offset:1024 sc1
    v_mfma_f32_16x16x32_bf16 v[196:199], v[32:35], a[204:207], v[196:199]
    s_add_u32 s63, s55, s56
    v_mul_f32 v169, v169, v145
    v_mul_f32 v170, v170, v146
    v_mfma_f32_16x16x32_bf16 v[196:199], v[36:39], a[220:223], v[196:199]
    s_waitcnt vmcnt(10)
    v_mul_f32 v171, v171, v147
    v_cvt_pk_bf16_f32 v236, v168, v169
    v_mfma_f32_16x16x32_bf16 v[184:187], v[40:43], a[224:227], v[184:187]
    v_mfma_f32_16x16x32_bf16 v[184:187], v[44:47], a[240:243], v[184:187]
    buffer_load_dwordx4 v[32:35], v20, s[24:27], s77 offen sc1
L_page4:
    s_cbranch_execz L_ret0
    v_mfma_f32_16x16x32_bf16 v[188:191], v[40:43], a[228:231], v[188:191]
    s_add_u32 s55, s34, 6
    v_cvt_pk_bf16_f32 v237, v170, v171
    v_min_u32 v236, -2, v236
    v_mfma_f32_16x16x32_bf16 v[188:191], v[44:47], a[244:247], v[188:191]
    v_min_u32 v237, -2, v237
    v_mfma_f32_16x16x32_bf16 v[192:195], v[40:43], a[232:235], v[192:195]
    s_and_b32 s55, s55, 7
    v_mfma_f32_16x16x32_bf16 v[192:195], v[44:47], a[248:251], v[192:195]
    buffer_load_dwordx4 v[36:39], v20, s[24:27], s77 offen offset:1024 sc1
    v_mfma_f32_16x16x32_bf16 v[196:199], v[40:43], a[236:239], v[196:199]
    v_mfma_f32_16x16x32_bf16 v[196:199], v[44:47], a[252:255], v[196:199]
    s_waitcnt vmcnt(10)
    s_mul_i32 s55, s55, 3072
    v_mfma_f32_16x16x32_bf16 v[168:171], v[48:51], a[0:3], v[128:131]
    v_mul_f32 v132, v152, v152
    v_mul_f32 v133, v153, v153
    v_mfma_f32_16x16x32_bf16 v[168:171], v[52:55], a[16:19], v[168:171]
    buffer_load_dwordx4 v[40:43], v20, s[24:27], s78 offen sc1
    v_mfma_f32_16x16x32_bf16 v[172:175], v[48:51], a[4:7], 0
    s_add_u32 s64, s55, s56
    v_mul_f32 v134, v154, v154
    v_mul_f32 v135, v155, v155
    v_mfma_f32_16x16x32_bf16 v[172:175], v[52:55], a[20:23], v[172:175]
    v_mfma_f32_16x16x32_bf16 v[176:179], v[48:51], a[8:11], 0
    s_add_u32 s55, s34, 7
    v_mfma_f32_16x16x32_bf16 v[176:179], v[52:55], a[24:27], v[176:179]
    buffer_load_dwordx4 v[44:47], v20, s[24:27], s78 offen offset:1024 sc1
    v_mfma_f32_16x16x32_bf16 v[180:183], v[48:51], a[12:15], 0
    ds_write_b128 v23, v[188:191] offset:12288
    v_mfma_f32_16x16x32_bf16 v[180:183], v[52:55], a[28:31], v[180:183]
    s_waitcnt vmcnt(10)
    v_fma_f32 v132, v132, s46, v2
    v_fma_f32 v133, v133, s46, v2
    v_mfma_f32_16x16x32_bf16 v[168:171], v[56:59], a[32:35], v[168:171]
    s_and_b32 s55, s55, 7
    v_fma_f32 v134, v134, s46, v2
    v_fma_f32 v135, v135, s46, v2
    v_mfma_f32_16x16x32_bf16 v[168:171], v[60:63], a[48:51], v[168:171]
    buffer_load_dwordx4 v[48:51], v20, s[24:27], s79 offen sc1
    v_mfma_f32_16x16x32_bf16 v[172:175], v[56:59], a[36:39], v[172:175]
    ds_write_b128 v24, v[192:195] offset:12288
    v_mfma_f32_16x16x32_bf16 v[172:175], v[60:63], a[52:55], v[172:175]
    s_mul_i32 s55, s55, 3072
    v_mul_f32 v132, v132, v152
    v_mul_f32 v133, v133, v153
    v_mfma_f32_16x16x32_bf16 v[176:179], v[56:59], a[40:43], v[176:179]
    ds_write_b128 v25, v[196:199] offset:12288
    v_mfma_f32_16x16x32_bf16 v[176:179], v[60:63], a[56:59], v[176:179]
    buffer_load_dwordx4 v[52:55], v20, s[24:27], s79 offen offset:1024 sc1
    v_mfma_f32_16x16x32_bf16 v[180:183], v[56:59], a[44:47], v[180:183]
    s_add_u32 s65, s55, s56
    v_mul_f32 v134, v134, v154
    v_mul_f32 v135, v135, v155
    v_mfma_f32_16x16x32_bf16 v[180:183], v[60:63], a[60:63], v[180:183]
    s_waitcnt vmcnt(10)
    v_mfma_f32_16x16x32_bf16 v[168:171], v[64:67], a[64:67], v[168:171]
    v_add_u32 v20, 0x10000, v20
    s_lshl1_add_u32 s54, s32, s34
    v_mfma_f32_16x16x32_bf16 v[168:171], v[68:71], a[80:83], v[168:171]
    buffer_load_dwordx4 v[56:59], v20, s[24:27], s72 offen sc1
    v_mfma_f32_16x16x32_bf16 v[172:175], v[64:67], a[68:71], v[172:175]
    v_exp_f32 v132, v132
    v_mfma_f32_16x16x32_bf16 v[172:175], v[68:71], a[84:87], v[172:175]
    s_mul_i32 s56, s34, 5120
    v_exp_f32 v133, v133
    v_mfma_f32_16x16x32_bf16 v[176:179], v[64:67], a[72:75], v[176:179]
    v_mfma_f32_16x16x32_bf16 v[176:179], v[68:71], a[88:91], v[176:179]
    buffer_load_dwordx4 v[60:63], v20, s[24:27], s72 offen offset:1024 sc1
    v_mfma_f32_16x16x32_bf16 v[180:183], v[64:67], a[76:79], v[180:183]
    s_waitcnt lgkmcnt(0)
    s_barrier
    s_add_u32 s56, s56, 7340032
    v_mfma_f32_16x16x32_bf16 v[180:183], v[68:71], a[92:95], v[180:183]
    s_waitcnt vmcnt(10)
    v_exp_f32 v134, v134
    v_mfma_f32_16x16x32_bf16 v[168:171], v[72:75], a[96:99], v[168:171]
    ds_read_b128 v[200:203], v26 offset:12288
    v_mfma_f32_16x16x32_bf16 v[168:171], v[76:79], a[112:115], v[168:171]
    buffer_load_dwordx4 v[64:67], v20, s[24:27], s73 offen sc1
    v_mfma_f32_16x16x32_bf16 v[172:175], v[72:75], a[100:103], v[172:175]
    s_add_u32 s55, s54, 0
    v_exp_f32 v135, v135
    v_mfma_f32_16x16x32_bf16 v[172:175], v[76:79], a[116:119], v[172:175]
    ds_read_b128 v[204:207], v26 offset:13312
    s_and_b32 s55, s55, 7
    v_mfma_f32_16x16x32_bf16 v[176:179], v[72:75], a[104:107], v[176:179]
    ds_read_b128 v[208:211], v26 offset:14336
    v_mfma_f32_16x16x32_bf16 v[176:179], v[76:79], a[120:123], v[176:179]
    buffer_load_dwordx4 v[68:71], v20, s[24:27], s73 offen offset:1024 sc1
    v_mfma_f32_16x16x32_bf16 v[180:183], v[72:75], a[108:111], v[180:183]
    s_mul_i32 s55, s55, 122880
    v_add_f32 v132, 1.0, v132
    v_add_f32 v133, 1.0, v133
    v_mfma_f32_16x16x32_bf16 v[180:183], v[76:79], a[124:127], v[180:183]
    s_waitcnt vmcnt(10)
    v_add_f32 v134, 1.0, v134
    v_add_f32 v135, 1.0, v135
    v_mfma_f32_16x16x32_bf16 v[168:171], v[80:83], a[128:131], v[168:171]
    v_mfma_f32_16x16x32_bf16 v[168:171], v[84:87], a[144:147], v[168:171]
    buffer_load_dwordx4 v[72:75], v20, s[24:27], s74 offen sc1
    v_mfma_f32_16x16x32_bf16 v[172:175], v[80:83], a[132:135], v[172:175]
    s_add_u32 s66, s55, s56
    v_rcp_f32 v132, v132
    v_mfma_f32_16x16x32_bf16 v[172:175], v[84:87], a[148:151], v[172:175]
    v_mfma_f32_16x16x32_bf16 v[176:179], v[80:83], a[136:139], v[176:179]
    s_add_u32 s55, s54, 1
    v_rcp_f32 v133, v133
    v_mfma_f32_16x16x32_bf16 v[176:179], v[84:87], a[152:155], v[176:179]
    buffer_load_dwordx4 v[76:79], v20, s[24:27], s74 offen offset:1024 sc1
    v_mfma_f32_16x16x32_bf16 v[180:183], v[80:83], a[140:143], v[180:183]
    s_waitcnt lgkmcnt(0)
    v_add_f32 v184, v184, v200
    v_mfma_f32_16x16x32_bf16 v[180:183], v[84:87], a[156:159], v[180:183]
    s_waitcnt vmcnt(10)
    v_rcp_f32 v134, v134
    v_mfma_f32_16x16x32_bf16 v[168:171], v[32:35], a[160:163], v[168:171]
    s_and_b32 s55, s55, 7
    v_add_f32 v185, v185, v201
    v_add_f32 v186, v186, v202
    v_mfma_f32_16x16x32_bf16 v[168:171], v[36:39], a[176:179], v[168:171]
    buffer_load_dwordx4 v[80:83], v20, s[24:27], s75 offen sc1
    v_mfma_f32_16x16x32_bf16 v[172:175], v[32:35], a[164:167], v[172:175]
    s_mul_i32 s55, s55, 122880
    v_rcp_f32 v135, v135
    v_mfma_f32_16x16x32_bf16 v[172:175], v[36:39], a[180:183], v[172:175]
    v_add_f32 v187, v187, v203
    v_add_f32 v184, v184, v204
    v_mfma_f32_16x16x32_bf16 v[176:179], v[32:35], a[168:171], v[176:179]
    v_add_f32 v185, v185, v205
    v_add_f32 v186, v186, v206
    v_mfma_f32_16x16x32_bf16 v[176:179], v[36:39], a[184:187], v[176:179]
    buffer_load_dwordx4 v[84:87], v20, s[24:27], s75 offen offset:1024 sc1
    v_mfma_f32_16x16x32_bf16 v[180:183], v[32:35], a[172:175], v[180:183]
    s_add_u32 s67, s55, s56
    v_mul_f32 v152, v152, v132
    v_mul_f32 v153, v153, v133
    v_mfma_f32_16x16x32_bf16 v[180:183], v[36:39], a[188:191], v[180:183]
    s_waitcnt vmcnt(10)
    v_add_f32 v187, v187, v207
    v_add_f32 v184, v184, v208
    v_mfma_f32_16x16x32_bf16 v[168:171], v[40:43], a[192:195], v[168:171]
    s_mul_i32 s68, s32, 10240
    v_mul_f32 v154, v154, v134
    v_mul_f32 v155, v155, v135
    v_mfma_f32_16x16x32_bf16 v[168:171], v[44:47], a[208:211], v[168:171]
    buffer_load_dwordx4 v[32:35], v20, s[24:27], s76 offen sc1
    v_mfma_f32_16x16x32_bf16 v[172:175], v[40:43], a[196:199], v[172:175]
    v_add_f32 v185, v185, v209
    v_add_f32 v186, v186, v210
    v_mfma_f32_16x16x32_bf16 v[172:175], v[44:47], a[212:215], v[172:175]
    v_add_f32 v187, v187, v211
    v_mul_f32 v184, v184, v148
    v_mfma_f32_16x16x32_bf16 v[176:179], v[40:43], a[200:203], v[176:179]
    v_mul_f32 v185, v185, v149
    v_mul_f32 v186, v186, v150
    v_mfma_f32_16x16x32_bf16 v[176:179], v[44:47], a[216:219], v[176:179]
    buffer_load_dwordx4 v[36:39], v20, s[24:27], s76 offen offset:1024 sc1
    v_mfma_f32_16x16x32_bf16 v[180:183], v[40:43], a[204:207], v[180:183]
    v_mul_f32 v187, v187, v151
    v_cvt_pk_bf16_f32 v238, v184, v185
    v_mfma_f32_16x16x32_bf16 v[180:183], v[44:47], a[220:223], v[180:183]
    s_waitcnt vmcnt(10)
    v_mfma_f32_16x16x32_bf16 v[168:171], v[48:51], a[224:227], v[168:171]
    v_cvt_pk_bf16_f32 v239, v186, v187
    v_min_u32 v238, -2, v238
    v_mfma_f32_16x16x32_bf16 v[168:171], v[52:55], a[240:243], v[168:171]
    buffer_load_dwordx4 v[40:43], v20, s[24:27], s77 offen sc1
    v_mfma_f32_16x16x32_bf16 v[172:175], v[48:51], a[228:231], v[172:175]
    v_min_u32 v239, -2, v239
    v_mfma_f32_16x16x32_bf16 v[172:175], v[52:55], a[244:247], v[172:175]
    v_mfma_f32_16x16x32_bf16 v[176:179], v[48:51], a[232:235], v[176:179]
    buffer_store_dwordx4 v[236:239], v21, s[24:27], s98 offen offset:0 sc1
    v_mfma_f32_16x16x32_bf16 v[176:179], v[52:55], a[248:251], v[176:179]
    buffer_load_dwordx4 v[44:47], v20, s[24:27], s77 offen offset:1024 sc1
    v_mfma_f32_16x16x32_bf16 v[180:183], v[48:51], a[236:239], v[180:183]
    v_mfma_f32_16x16x32_bf16 v[180:183], v[52:55], a[252:255], v[180:183]
    s_waitcnt vmcnt(11)
    v_mfma_f32_16x16x32_bf16 v[184:187], v[56:59], a[0:3], v[128:131]
    v_mul_f32 v132, v156, v156
    v_mul_f32 v133, v157, v157
    v_mfma_f32_16x16x32_bf16 v[184:187], v[60:63], a[16:19], v[184:187]
    buffer_load_dwordx4 v[48:51], v20, s[24:27], s78 offen sc1
    v_mfma_f32_16x16x32_bf16 v[188:191], v[56:59], a[4:7], 0
    v_mul_f32 v134, v158, v158
    v_mul_f32 v135, v159, v159
    v_mfma_f32_16x16x32_bf16 v[188:191], v[60:63], a[20:23], v[188:191]
    v_mfma_f32_16x16x32_bf16 v[192:195], v[56:59], a[8:11], 0
    v_mfma_f32_16x16x32_bf16 v[192:195], v[60:63], a[24:27], v[192:195]
    buffer_load_dwordx4 v[52:55], v20, s[24:27], s78 offen offset:1024 sc1
    v_mfma_f32_16x16x32_bf16 v[196:199], v[56:59], a[12:15], 0
    ds_write_b128 v23, v[172:175] offset:0
    v_mfma_f32_16x16x32_bf16 v[196:199], v[60:63], a[28:31], v[196:199]
    s_waitcnt vmcnt(11)
    v_fma_f32 v132, v132, s46, v2
    v_fma_f32 v133, v133, s46, v2
    v_mfma_f32_16x16x32_bf16 v[184:187], v[64:67], a[32:35], v[184:187]
    v_fma_f32 v134, v134, s46, v2
    v_fma_f32 v135, v135, s46, v2
    v_mfma_f32_16x16x32_bf16 v[184:187], v[68:71], a[48:51], v[184:187]
    buffer_load_dwordx4 v[56:59], v20, s[24:27], s79 offen sc1
    v_mfma_f32_16x16x32_bf16 v[188:191], v[64:67], a[36:39], v[188:191]
    ds_write_b128 v24, v[176:179] offset:0
    v_mfma_f32_16x16x32_bf16 v[188:191], v[68:71], a[52:55], v[188:191]
    v_mul_f32 v132, v132, v156
    v_mul_f32 v133, v133, v157
    v_mfma_f32_16x16x32_bf16 v[192:195], v[64:67], a[40:43], v[192:195]
    ds_write_b128 v25, v[180:183] offset:0
    v_mfma_f32_16x16x32_bf16 v[192:195], v[68:71], a[56:59], v[192:195]
    buffer_load_dwordx4 v[60:63], v20, s[24:27], s79 offen offset:1024 sc1
    v_mfma_f32_16x16x32_bf16 v[196:199], v[64:67], a[44:47], v[196:199]
    v_mul_f32 v134, v134, v158
    v_mul_f32 v135, v135, v159
    v_mfma_f32_16x16x32_bf16 v[196:199], v[68:71], a[60:63], v[196:199]
    s_waitcnt vmcnt(11)
    v_mfma_f32_16x16x32_bf16 v[184:187], v[72:75], a[64:67], v[184:187]
    v_add_u32 v20, 0x10000, v20
    v_mfma_f32_16x16x32_bf16 v[184:187], v[76:79], a[80:83], v[184:187]
    buffer_load_dwordx4 v[64:67], v20, s[24:27], s72 offen sc1
    v_mfma_f32_16x16x32_bf16 v[188:191], v[72:75], a[68:71], v[188:191]
    v_exp_f32 v132, v132
    v_mfma_f32_16x16x32_bf16 v[188:191], v[76:79], a[84:87], v[188:191]
    v_exp_f32 v133, v133
    v_mfma_f32_16x16x32_bf16 v[192:195], v[72:75], a[72:75], v[192:195]
    v_mfma_f32_16x16x32_bf16 v[192:195], v[76:79], a[88:91], v[192:195]
    buffer_load_dwordx4 v[68:71], v20, s[24:27], s72 offen offset:1024 sc1
    v_mfma_f32_16x16x32_bf16 v[196:199], v[72:75], a[76:79], v[196:199]
    s_waitcnt lgkmcnt(0)
    s_barrier
    v_mfma_f32_16x16x32_bf16 v[196:199], v[76:79], a[92:95], v[196:199]
    s_waitcnt vmcnt(11)
    v_exp_f32 v134, v134
    v_mfma_f32_16x16x32_bf16 v[184:187], v[80:83], a[96:99], v[184:187]
    ds_read_b128 v[200:203], v26 offset:0
    v_mfma_f32_16x16x32_bf16 v[184:187], v[84:87], a[112:115], v[184:187]
    buffer_load_dwordx4 v[72:75], v20, s[24:27], s73 offen sc1
    v_mfma_f32_16x16x32_bf16 v[188:191], v[80:83], a[100:103], v[188:191]
    ds_read_b128 v[204:207], v26 offset:1024
    v_mfma_f32_16x16x32_bf16 v[188:191], v[84:87], a[116:119], v[188:191]
    v_exp_f32 v135, v135
    v_mfma_f32_16x16x32_bf16 v[192:195], v[80:83], a[104:107], v[192:195]
    ds_read_b128 v[208:211], v26 offset:2048
    v_mfma_f32_16x16x32_bf16 v[192:195], v[84:87], a[120:123], v[192:195]
    buffer_load_dwordx4 v[76:79], v20, s[24:27], s73 offen offset:1024 sc1
    v_mfma_f32_16x16x32_bf16 v[196:199], v[80:83], a[108:111], v[196:199]
    v_add_f32 v132, 1.0, v132
    v_add_f32 v133, 1.0, v133
    v_mfma_f32_16x16x32_bf16 v[196:199], v[84:87], a[124:127], v[196:199]
    s_waitcnt vmcnt(11)
    v_add_f32 v134, 1.0, v134
    v_add_f32 v135, 1.0, v135
    v_mfma_f32_16x16x32_bf16 v[184:187], v[32:35], a[128:131], v[184:187]
    v_mfma_f32_16x16x32_bf16 v[184:187], v[36:39], a[144:147], v[184:187]
    buffer_load_dwordx4 v[80:83], v20, s[24:27], s74 offen sc1
    v_mfma_f32_16x16x32_bf16 v[188:191], v[32:35], a[132:135], v[188:191]
    v_rcp_f32 v132, v132
    v_mfma_f32_16x16x32_bf16 v[188:191], v[36:39], a[148:151], v[188:191]
    v_mfma_f32_16x16x32_bf16 v[192:195], v[32:35], a[136:139], v[192:195]
    v_rcp_f32 v133, v133
    v_mfma_f32_16x16x32_bf16 v[192:195], v[36:39], a[152:155], v[192:195]
    buffer_load_dwordx4 v[84:87], v20, s[24:27], s74 offen offset:1024 sc1
    v_mfma_f32_16x16x32_bf16 v[196:199], v[32:35], a[140:143], v[196:199]
    s_waitcnt lgkmcnt(0)
    v_add_f32 v168, v168, v200
    v_mfma_f32_16x16x32_bf16 v[196:199], v[36:39], a[156:159], v[196:199]
    s_waitcnt vmcnt(10)
    v_rcp_f32 v134, v134
    v_mfma_f32_16x16x32_bf16 v[184:187], v[40:43], a[160:163], v[184:187]
    v_add_f32 v169, v169, v201
    v_add_f32 v170, v170, v202
    v_mfma_f32_16x16x32_bf16 v[184:187], v[44:47], a[176:179], v[184:187]
    buffer_load_dwordx4 v[32:35], v20, s[24:27], s75 offen sc1
    v_mfma_f32_16x16x32_bf16 v[188:191], v[40:43], a[164:167], v[188:191]
    v_rcp_f32 v135, v135
    v_mfma_f32_16x16x32_bf16 v[188:191], v[44:47], a[180:183], v[188:191]
    v_add_f32 v171, v171, v203
    v_add_f32 v168, v168, v204
    v_mfma_f32_16x16x32_bf16 v[192:195], v[40:43], a[168:171], v[192:195]
    v_mul_f32 v156, v156, v132
    v_mul_f32 v157, v157, v133
    v_mfma_f32_16x16x32_bf16 v[192:195], v[44:47], a[184:187], v[192:195]
    buffer_load_dwordx4 v[36:39], v20, s[24:27], s75 offen offset:1024 sc1
    v_mfma_f32_16x16x32_bf16 v[196:199], v[40:43], a[172:175], v[196:199]
    v_add_f32 v169, v169, v205
    v_add_f32 v170, v170, v206
    v_mfma_f32_16x16x32_bf16 v[196:199], v[44:47], a[188:191], v[196:199]
    s_waitcnt vmcnt(10)
    v_add_f32 v171, v171, v207
    v_add_f32 v168, v168, v208
    v_mfma_f32_16x16x32_bf16 v[184:187], v[48:51], a[192:195], v[184:187]
    v_mul_f32 v158, v158, v134
    v_mul_f32 v159, v159, v135
    v_mfma_f32_16x16x32_bf16 v[184:187], v[52:55], a[208:211], v[184:187]
    buffer_load_dwordx4 v[40:43], v20, s[24:27], s76 offen sc1
    v_mfma_f32_16x16x32_bf16 v[188:191], v[48:51], a[196:199], v[188:191]
    v_add_f32 v169, v169, v209
    v_add_f32 v170, v170, v210
    v_mfma_f32_16x16x32_bf16 v[188:191], v[52:55], a[212:215], v[188:191]
    v_add_f32 v171, v171, v211
    v_mul_f32 v168, v168, v152
    v_mfma_f32_16x16x32_bf16 v[192:195], v[48:51], a[200:203], v[192:195]
    v_mfma_f32_16x16x32_bf16 v[192:195], v[52:55], a[216:219], v[192:195]
    buffer_load_dwordx4 v[44:47], v20, s[24:27], s76 offen offset:1024 sc1
    v_mfma_f32_16x16x32_bf16 v[196:199], v[48:51], a[204:207], v[196:199]
    v_mul_f32 v169, v169, v153
    v_mul_f32 v170, v170, v154
    v_mfma_f32_16x16x32_bf16 v[196:199], v[52:55], a[220:223], v[196:199]
    s_waitcnt vmcnt(10)
    v_mul_f32 v171, v171, v155
    v_cvt_pk_bf16_f32 v240, v168, v169
    v_mfma_f32_16x16x32_bf16 v[184:187], v[56:59], a[224:227], v[184:187]
    v_mfma_f32_16x16x32_bf16 v[184:187], v[60:63], a[240:243], v[184:187]
    buffer_load_dwordx4 v[48:51], v20, s[24:27], s77 offen sc1
    v_mfma_f32_16x16x32_bf16 v[188:191], v[56:59], a[228:231], v[188:191]
    v_cvt_pk_bf16_f32 v241, v170, v171
    v_min_u32 v240, -2, v240
    v_mfma_f32_16x16x32_bf16 v[188:191], v[60:63], a[244:247], v[188:191]
    v_min_u32 v241, -2, v241
    v_mfma_f32_16x16x32_bf16 v[192:195], v[56:59], a[232:235], v[192:195]
    v_mfma_f32_16x16x32_bf16 v[192:195], v[60:63], a[248:251], v[192:195]
    buffer_load_dwordx4 v[52:55], v20, s[24:27], s77 offen offset:1024 sc1
    v_mfma_f32_16x16x32_bf16 v[196:199], v[56:59], a[236:239], v[196:199]
    v_mfma_f32_16x16x32_bf16 v[196:199], v[60:63], a[252:255], v[196:199]
    s_waitcnt vmcnt(10)
    v_mfma_f32_16x16x32_bf16 v[168:171], v[64:67], a[0:3], v[128:131]
    v_mul_f32 v132, v160, v160
    v_mul_f32 v133, v161, v161
    v_mfma_f32_16x16x32_bf16 v[168:171], v[68:71], a[16:19], v[168:171]
    buffer_load_dwordx4 v[56:59], v20, s[24:27], s78 offen sc1
    v_mfma_f32_16x16x32_bf16 v[172:175], v[64:67], a[4:7], 0
    v_mul_f32 v134, v162, v162
    v_mul_f32 v135, v163, v163
    v_mfma_f32_16x16x32_bf16 v[172:175], v[68:71], a[20:23], v[172:175]
    v_mfma_f32_16x16x32_bf16 v[176:179], v[64:67], a[8:11], 0
    v_mfma_f32_16x16x32_bf16 v[176:179], v[68:71], a[24:27], v[176:179]
    buffer_load_dwordx4 v[60:63], v20, s[24:27], s78 offen offset:1024 sc1
    v_mfma_f32_16x16x32_bf16 v[180:183], v[64:67], a[12:15], 0
    ds_write_b128 v23, v[188:191] offset:12288
    v_mfma_f32_16x16x32_bf16 v[180:183], v[68:71], a[28:31], v[180:183]
    s_waitcnt vmcnt(10)
    v_fma_f32 v132, v132, s46, v2
    v_fma_f32 v133, v133, s46, v2
    v_mfma_f32_16x16x32_bf16 v[168:171], v[72:75], a[32:35], v[168:171]
    v_fma_f32 v134, v134, s46, v2
    v_fma_f32 v135, v135, s46, v2
    v_mfma_f32_16x16x32_bf16 v[168:171], v[76:79], a[48:51], v[168:171]
    buffer_load_dwordx4 v[64:67], v20, s[24:27], s79 offen sc1
    v_mfma_f32_16x16x32_bf16 v[172:175], v[72:75], a[36:39], v[172:175]
    ds_write_b128 v24, v[192:195] offset:12288
    v_mfma_f32_16x16x32_bf16 v[172:175], v[76:79], a[52:55], v[172:175]
    v_mul_f32 v132, v132, v160
    v_mul_f32 v133, v133, v161
    v_mfma_f32_16x16x32_bf16 v[176:179], v[72:75], a[40:43], v[176:179]
    ds_write_b128 v25, v[196:199] offset:12288
    v_mfma_f32_16x16x32_bf16 v[176:179], v[76:79], a[56:59], v[176:179]
    buffer_load_dwordx4 v[68:71], v20, s[24:27], s79 offen offset:1024 sc1
    v_mfma_f32_16x16x32_bf16 v[180:183], v[72:75], a[44:47], v[180:183]
    v_mul_f32 v134, v134, v162
    v_mul_f32 v135, v135, v163
    v_mfma_f32_16x16x32_bf16 v[180:183], v[76:79], a[60:63], v[180:183]
    s_waitcnt vmcnt(10)
    v_mfma_f32_16x16x32_bf16 v[168:171], v[80:83], a[64:67], v[168:171]
    v_add_u32 v20, 0x10000, v20
    v_mfma_f32_16x16x32_bf16 v[168:171], v[84:87], a[80:83], v[168:171]
    buffer_load_dwordx4 v[72:75], v20, s[24:27], s72 offen sc1
    v_mfma_f32_16x16x32_bf16 v[172:175], v[80:83], a[68:71], v[172:175]
    v_exp_f32 v132, v132
    v_mfma_f32_16x16x32_bf16 v[172:175], v[84:87], a[84:87], v[172:175]
    v_exp_f32 v133, v133
    v_mfma_f32_16x16x32_bf16 v[176:179], v[80:83], a[72:75], v[176:179]
    v_mfma_f32_16x16x32_bf16 v[176:179], v[84:87], a[88:91], v[176:179]
    buffer_load_dwordx4 v[76:79], v20, s[24:27], s72 offen offset:1024 sc1
    v_mfma_f32_16x16x32_bf16 v[180:183], v[80:83], a[76:79], v[180:183]
    s_waitcnt lgkmcnt(0)
    s_barrier
    v_mfma_f32_16x16x32_bf16 v[180:183], v[84:87], a[92:95], v[180:183]
    s_waitcnt vmcnt(10)
    v_exp_f32 v134, v134
    v_mfma_f32_16x16x32_bf16 v[168:171], v[32:35], a[96:99], v[168:171]
    ds_read_b128 v[200:203], v26 offset:12288
    v_mfma_f32_16x16x32_bf16 v[168:171], v[36:39], a[112:115], v[168:171]
    buffer_load_dwordx4 v[80:83], v20, s[24:27], s73 offen sc1
    v_mfma_f32_16x16x32_bf16 v[172:175], v[32:35], a[100:103], v[172:175]
    ds_read_b128 v[204:207], v26 offset:13312
    v_mfma_f32_16x16x32_bf16 v[172:175], v[36:39], a[116:119], v[172:175]
    v_exp_f32 v135, v135
    v_mfma_f32_16x16x32_bf16 v[176:179], v[32:35], a[104:107], v[176:179]
    ds_read_b128 v[208:211], v26 offset:14336
    v_mfma_f32_16x16x32_bf16 v[176:179], v[36:39], a[120:123], v[176:179]
    buffer_load_dwordx4 v[84:87], v20, s[24:27], s73 offen offset:1024 sc1
    v_mfma_f32_16x16x32_bf16 v[180:183], v[32:35], a[108:111], v[180:183]
    v_add_f32 v132, 1.0, v132
    v_add_f32 v133, 1.0, v133
    v_mfma_f32_16x16x32_bf16 v[180:183], v[36:39], a[124:127], v[180:183]
    s_waitcnt vmcnt(10)
    v_add_f32 v134, 1.0, v134
    v_add_f32 v135, 1.0, v135
    v_mfma_f32_16x16x32_bf16 v[168:171], v[40:43], a[128:131], v[168:171]
    v_mfma_f32_16x16x32_bf16 v[168:171], v[44:47], a[144:147], v[168:171]
    buffer_load_dwordx4 v[32:35], v20, s[24:27], s74 offen sc1
    v_mfma_f32_16x16x32_bf16 v[172:175], v[40:43], a[132:135], v[172:175]
    v_rcp_f32 v132, v132
    v_mfma_f32_16x16x32_bf16 v[172:175], v[44:47], a[148:151], v[172:175]
    v_mfma_f32_16x16x32_bf16 v[176:179], v[40:43], a[136:139], v[176:179]
    v_rcp_f32 v133, v133
    v_mfma_f32_16x16x32_bf16 v[176:179], v[44:47], a[152:155], v[176:179]
    buffer_load_dwordx4 v[36:39], v20, s[24:27], s74 offen offset:1024 sc1
    v_mfma_f32_16x16x32_bf16 v[180:183], v[40:43], a[140:143], v[180:183]
    s_waitcnt lgkmcnt(0)
    v_add_f32 v184, v184, v200
    v_mfma_f32_16x16x32_bf16 v[180:183], v[44:47], a[156:159], v[180:183]
    s_waitcnt vmcnt(10)
    v_rcp_f32 v134, v134
    v_mfma_f32_16x16x32_bf16 v[168:171], v[48:51], a[160:163], v[168:171]
    v_add_f32 v185, v185, v201
    v_add_f32 v186, v186, v202
    v_mfma_f32_16x16x32_bf16 v[168:171], v[52:55], a[176:179], v[168:171]
    buffer_load_dwordx4 v[40:43], v20, s[24:27], s75 offen sc1
    v_mfma_f32_16x16x32_bf16 v[172:175], v[48:51], a[164:167], v[172:175]
    v_rcp_f32 v135, v135
    v_mfma_f32_16x16x32_bf16 v[172:175], v[52:55], a[180:183], v[172:175]
    v_add_f32 v187, v187, v203
    v_add_f32 v184, v184, v204
    v_mfma_f32_16x16x32_bf16 v[176:179], v[48:51], a[168:171], v[176:179]
    v_add_f32 v185, v185, v205
    v_add_f32 v186, v186, v206
    v_mfma_f32_16x16x32_bf16 v[176:179], v[52:55], a[184:187], v[176:179]
    buffer_load_dwordx4 v[44:47], v20, s[24:27], s75 offen offset:1024 sc1
    v_mfma_f32_16x16x32_bf16 v[180:183], v[48:51], a[172:175], v[180:183]
    v_mul_f32 v160, v160, v132
    v_mul_f32 v161, v161, v133
    v_mfma_f32_16x16x32_bf16 v[180:183], v[52:55], a[188:191], v[180:183]
    s_waitcnt vmcnt(10)
    v_add_f32 v187, v187, v207
    v_add_f32 v184, v184, v208
    v_mfma_f32_16x16x32_bf16 v[168:171], v[56:59], a[192:195], v[168:171]
    v_mul_f32 v162, v162, v134
    v_mul_f32 v163, v163, v135
    v_mfma_f32_16x16x32_bf16 v[168:171], v[60:63], a[208:211], v[168:171]
    buffer_load_dwordx4 v[48:51], v20, s[24:27], s76 offen sc1
    v_mfma_f32_16x16x32_bf16 v[172:175], v[56:59], a[196:199], v[172:175]
    v_add_f32 v185, v185, v209
    v_add_f32 v186, v186, v210
    v_mfma_f32_16x16x32_bf16 v[172:175], v[60:63], a[212:215], v[172:175]
    v_add_f32 v187, v187, v211
    v_mul_f32 v184, v184, v156
    v_mfma_f32_16x16x32_bf16 v[176:179], v[56:59], a[200:203], v[176:179]
    v_mul_f32 v185, v185, v157
    v_mul_f32 v186, v186, v158
    v_mfma_f32_16x16x32_bf16 v[176:179], v[60:63], a[216:219], v[176:179]
    buffer_load_dwordx4 v[52:55], v20, s[24:27], s76 offen offset:1024 sc1
    v_mfma_f32_16x16x32_bf16 v[180:183], v[56:59], a[204:207], v[180:183]
    v_mul_f32 v187, v187, v159
    v_cvt_pk_bf16_f32 v242, v184, v185
    v_mfma_f32_16x16x32_bf16 v[180:183], v[60:63], a[220:223], v[180:183]
    s_waitcnt vmcnt(10)
    v_mfma_f32_16x16x32_bf16 v[168:171], v[64:67], a[224:227], v[168:171]
    v_cvt_pk_bf16_f32 v243, v186, v187
    v_min_u32 v242, -2, v242
    v_mfma_f32_16x16x32_bf16 v[168:171], v[68:71], a[240:243], v[168:171]
    buffer_load_dwordx4 v[56:59], v20, s[24:27], s77 offen sc1
    v_mfma_f32_16x16x32_bf16 v[172:175], v[64:67], a[228:231], v[172:175]
    v_min_u32 v243, -2, v243
    v_mfma_f32_16x16x32_bf16 v[172:175], v[68:71], a[244:247], v[172:175]
    v_mfma_f32_16x16x32_bf16 v[176:179], v[64:67], a[232:235], v[176:179]
    buffer_store_dwordx4 v[240:243], v21, s[24:27], s98 offen offset:1024 sc1
    v_mfma_f32_16x16x32_bf16 v[176:179], v[68:71], a[248:251], v[176:179]
    buffer_load_dwordx4 v[60:63], v20, s[24:27], s77 offen offset:1024 sc1
    v_mfma_f32_16x16x32_bf16 v[180:183], v[64:67], a[236:239], v[180:183]
    v_mfma_f32_16x16x32_bf16 v[180:183], v[68:71], a[252:255], v[180:183]
    s_waitcnt vmcnt(11)
    v_mfma_f32_16x16x32_bf16 v[184:187], v[72:75], a[0:3], v[128:131]
    v_mul_f32 v132, v164, v164
    v_mul_f32 v133, v165, v165
    v_mfma_f32_16x16x32_bf16 v[184:187], v[76:79], a[16:19], v[184:187]
    buffer_load_dwordx4 v[64:67], v20, s[24:27], s78 offen sc1
    v_mfma_f32_16x16x32_bf16 v[188:191], v[72:75], a[4:7], 0
    v_mul_f32 v134, v166, v166
    v_mul_f32 v135, v167, v167
    v_mfma_f32_16x16x32_bf16 v[188:191], v[76:79], a[20:23], v[188:191]
    v_mfma_f32_16x16x32_bf16 v[192:195], v[72:75], a[8:11], 0
    v_mfma_f32_16x16x32_bf16 v[192:195], v[76:79], a[24:27], v[192:195]
    buffer_load_dwordx4 v[68:71], v20, s[24:27], s78 offen offset:1024 sc1
    v_mfma_f32_16x16x32_bf16 v[196:199], v[72:75], a[12:15], 0
    ds_write_b128 v23, v[172:175] offset:0
    v_mfma_f32_16x16x32_bf16 v[196:199], v[76:79], a[28:31], v[196:199]
    s_waitcnt vmcnt(11)
    v_fma_f32 v132, v132, s46, v2
    v_fma_f32 v133, v133, s46, v2
    v_mfma_f32_16x16x32_bf16 v[184:187], v[80:83], a[32:35], v[184:187]
    v_fma_f32 v134, v134, s46, v2
    v_fma_f32 v135, v135, s46, v2
    v_mfma_f32_16x16x32_bf16 v[184:187], v[84:87], a[48:51], v[184:187]
    buffer_load_dwordx4 v[72:75], v20, s[24:27], s79 offen sc1
    v_mfma_f32_16x16x32_bf16 v[188:191], v[80:83], a[36:39], v[188:191]
    ds_write_b128 v24, v[176:179] offset:0
    v_mfma_f32_16x16x32_bf16 v[188:191], v[84:87], a[52:55], v[188:191]
    v_mul_f32 v132, v132, v164
    v_mul_f32 v133, v133, v165
    v_mfma_f32_16x16x32_bf16 v[192:195], v[80:83], a[40:43], v[192:195]
    ds_write_b128 v25, v[180:183] offset:0
    v_mfma_f32_16x16x32_bf16 v[192:195], v[84:87], a[56:59], v[192:195]
    buffer_load_dwordx4 v[76:79], v20, s[24:27], s79 offen offset:1024 sc1
    v_mfma_f32_16x16x32_bf16 v[196:199], v[80:83], a[44:47], v[196:199]
    v_mul_f32 v134, v134, v166
    v_mul_f32 v135, v135, v167
    v_mfma_f32_16x16x32_bf16 v[196:199], v[84:87], a[60:63], v[196:199]
    s_waitcnt vmcnt(11)
    v_mfma_f32_16x16x32_bf16 v[184:187], v[32:35], a[64:67], v[184:187]
    v_exp_f32 v132, v132
    v_mfma_f32_16x16x32_bf16 v[184:187], v[36:39], a[80:83], v[184:187]
    v_mfma_f32_16x16x32_bf16 v[188:191], v[32:35], a[68:71], v[188:191]
    s_add_u32 m0, s68, 0
    s_add_u32 s38, s66, 0
    buffer_load_dwordx4 v21, s[24:27], s38 offen sc1 lds
    v_mfma_f32_16x16x32_bf16 v[188:191], v[36:39], a[84:87], v[188:191]
    v_exp_f32 v133, v133
    v_mfma_f32_16x16x32_bf16 v[192:195], v[32:35], a[72:75], v[192:195]
    v_mfma_f32_16x16x32_bf16 v[192:195], v[36:39], a[88:91], v[192:195]
    buffer_load_dwordx4 v21, s[24:27], s38 offen offset:1024 sc1 lds
    v_mfma_f32_16x16x32_bf16 v[196:199], v[32:35], a[76:79], v[196:199]
    s_waitcnt lgkmcnt(0)
    s_barrier
    v_mfma_f32_16x16x32_bf16 v[196:199], v[36:39], a[92:95], v[196:199]
    s_waitcnt vmcnt(11)
    v_exp_f32 v134, v134
    v_mfma_f32_16x16x32_bf16 v[184:187], v[40:43], a[96:99], v[184:187]
    ds_read_b128 v[200:203], v26 offset:0
    v_mfma_f32_16x16x32_bf16 v[184:187], v[44:47], a[112:115], v[184:187]
    buffer_load_dwordx4 v21, s[24:27], s38 offen offset:2048 sc1 lds
    v_mfma_f32_16x16x32_bf16 v[188:191], v[40:43], a[100:103], v[188:191]
    ds_read_b128 v[204:207], v26 offset:1024
    v_mfma_f32_16x16x32_bf16 v[188:191], v[44:47], a[116:119], v[188:191]
    v_exp_f32 v135, v135
    v_mfma_f32_16x16x32_bf16 v[192:195], v[40:43], a[104:107], v[192:195]
    ds_read_b128 v[208:211], v26 offset:2048
    v_mfma_f32_16x16x32_bf16 v[192:195], v[44:47], a[120:123], v[192:195]
    buffer_load_dwordx4 v21, s[24:27], s38 offen offset:3072 sc1 lds
    s_add_u32 m0, s68, 4096
    s_add_u32 s38, s66, 4096
    v_mfma_f32_16x16x32_bf16 v[196:199], v[40:43], a[108:111], v[196:199]
    v_add_f32 v132, 1.0, v132
    v_add_f32 v133, 1.0, v133
    v_mfma_f32_16x16x32_bf16 v[196:199], v[44:47], a[124:127], v[196:199]
    s_waitcnt vmcnt(11)
    v_add_f32 v134, 1.0, v134
    v_add_f32 v135, 1.0, v135
    v_mfma_f32_16x16x32_bf16 v[184:187], v[48:51], a[128:131], v[184:187]
    v_mfma_f32_16x16x32_bf16 v[184:187], v[52:55], a[144:147], v[184:187]
    buffer_load_dwordx4 v21, s[24:27], s38 offen sc1 lds
    s_add_u32 m0, s68, 5120
    s_add_u32 s38, s67, 0
    v_mfma_f32_16x16x32_bf16 v[188:191], v[48:51], a[132:135], v[188:191]
    v_rcp_f32 v132, v132
    v_mfma_f32_16x16x32_bf16 v[188:191], v[52:55], a[148:151], v[188:191]
    v_mfma_f32_16x16x32_bf16 v[192:195], v[48:51], a[136:139], v[192:195]
    buffer_load_dwordx4 v21, s[24:27], s38 offen sc1 lds
    v_mfma_f32_16x16x32_bf16 v[192:195], v[52:55], a[152:155], v[192:195]
    v_rcp_f32 v133, v133
    v_mfma_f32_16x16x32_bf16 v[196:199], v[48:51], a[140:143], v[196:199]
    s_waitcnt lgkmcnt(0)
    v_add_f32 v168, v168, v200
    v_mfma_f32_16x16x32_bf16 v[196:199], v[52:55], a[156:159], v[196:199]
    s_waitcnt vmcnt(10)
    v_rcp_f32 v134, v134
    v_mfma_f32_16x16x32_bf16 v[184:187], v[56:59], a[160:163], v[184:187]
    buffer_load_dwordx4 v21, s[24:27], s38 offen offset:1024 sc1 lds
    v_mfma_f32_16x16x32_bf16 v[184:187], v[60:63], a[176:179], v[184:187]
    v_add_f32 v169, v169, v201
    v_add_f32 v170, v170, v202
    v_mfma_f32_16x16x32_bf16 v[188:191], v[56:59], a[164:167], v[188:191]
    v_rcp_f32 v135, v135
    v_mfma_f32_16x16x32_bf16 v[188:191], v[60:63], a[180:183], v[188:191]
    v_add_f32 v171, v171, v203
    v_add_f32 v168, v168, v204
    v_mfma_f32_16x16x32_bf16 v[192:195], v[56:59], a[168:171], v[192:195]
    buffer_load_dwordx4 v21, s[24:27], s38 offen offset:2048 sc1 lds
    v_mfma_f32_16x16x32_bf16 v[192:195], v[60:63], a[184:187], v[192:195]
    v_mul_f32 v164, v164, v132
    v_mul_f32 v165, v165, v133
    v_mfma_f32_16x16x32_bf16 v[196:199], v[56:59], a[172:175], v[196:199]
    v_add_f32 v169, v169, v205
    v_add_f32 v170, v170, v206
    v_mfma_f32_16x16x32_bf16 v[196:199], v[60:63], a[188:191], v[196:199]
    s_waitcnt vmcnt(10)
    v_add_f32 v171, v171, v207
    v_add_f32 v168, v168, v208
    v_mfma_f32_16x16x32_bf16 v[184:187], v[64:67], a[192:195], v[184:187]
    buffer_load_dwordx4 v21, s[24:27], s38 offen offset:3072 sc1 lds
    s_add_u32 m0, s68, 9216
    s_add_u32 s38, s67, 4096
    v_mfma_f32_16x16x32_bf16 v[184:187], v[68:71], a[208:211], v[184:187]
    v_mul_f32 v166, v166, v134
    v_mul_f32 v167, v167, v135
    v_mfma_f32_16x16x32_bf16 v[188:191], v[64:67], a[196:199], v[188:191]
    v_add_f32 v169, v169, v209
    v_add_f32 v170, v170, v210
    v_mfma_f32_16x16x32_bf16 v[188:191], v[68:71], a[212:215], v[188:191]
    buffer_load_dwordx4 v21, s[24:27], s38 offen sc1 lds
    s_add_u32 m0, s68, 40960
    s_add_u32 s38, s66, 40960
    v_mfma_f32_16x16x32_bf16 v[192:195], v[64:67], a[200:203], v[192:195]
    v_add_f32 v171, v171, v211
    v_mul_f32 v168, v168, v160
    v_mfma_f32_16x16x32_bf16 v[192:195], v[68:71], a[216:219], v[192:195]
    v_mul_f32 v169, v169, v161
    v_mul_f32 v170, v170, v162
    v_mfma_f32_16x16x32_bf16 v[196:199], v[64:67], a[204:207], v[196:199]
    v_mfma_f32_16x16x32_bf16 v[196:199], v[68:71], a[220:223], v[196:199]
    s_waitcnt vmcnt(10)
    v_mul_f32 v171, v171, v163
    v_cvt_pk_bf16_f32 v244, v168, v169
    v_mfma_f32_16x16x32_bf16 v[184:187], v[72:75], a[224:227], v[184:187]
    buffer_load_dwordx4 v21, s[24:27], s38 offen sc1 lds
    v_mfma_f32_16x16x32_bf16 v[184:187], v[76:79], a[240:243], v[184:187]
    v_cvt_pk_bf16_f32 v245, v170, v171
    v_min_u32 v244, -2, v244
    v_mfma_f32_16x16x32_bf16 v[188:191], v[72:75], a[228:231], v[188:191]
    v_mfma_f32_16x16x32_bf16 v[188:191], v[76:79], a[244:247], v[188:191]
    buffer_load_dwordx4 v21, s[24:27], s38 offen offset:1024 sc1 lds
    v_mfma_f32_16x16x32_bf16 v[192:195], v[72:75], a[232:235], v[192:195]
    v_min_u32 v245, -2, v245
    v_mfma_f32_16x16x32_bf16 v[192:195], v[76:79], a[248:251], v[192:195]
    v_mfma_f32_16x16x32_bf16 v[196:199], v[72:75], a[236:239], v[196:199]
    v_mfma_f32_16x16x32_bf16 v[196:199], v[76:79], a[252:255], v[196:199]
    buffer_load_dwordx4 v[100:103], v21, s[24:27], s59 offen offset:0 sc1
L_page5:
    s_cbranch_execz L_ret1
    s_nop 0
    ds_write_b128 v23, v[188:191] offset:12288
    buffer_load_dwordx4 v[104:107], v21, s[24:27], s60 offen offset:0 sc1
    s_nop 1
    ds_write_b128 v24, v[192:195] offset:12288
    buffer_load_dwordx4 v[108:111], v21, s[24:27], s61 offen offset:0 sc1
    ds_write_b128 v25, v[196:199] offset:12288
    buffer_load_dwordx4 v[112:115], v21, s[24:27], s62 offen offset:0 sc1
    s_waitcnt lgkmcnt(0)
    s_barrier
    ds_read_b128 v[200:203], v26 offset:12288
    ds_read_b128 v[204:207], v26 offset:13312
    ds_read_b128 v[208:211], v26 offset:14336
    buffer_load_dwordx4 v[116:119], v21, s[24:27], s63 offen offset:0 sc1
    s_waitcnt lgkmcnt(2)
    v_pk_add_f32 v[184:185], v[184:185], v[200:201]
    v_pk_add_f32 v[186:187], v[186:187], v[202:203]
    s_waitcnt lgkmcnt(1)
    v_pk_add_f32 v[184:185], v[184:185], v[204:205]
    v_pk_add_f32 v[186:187], v[186:187], v[206:207]
    buffer_load_dwordx4 v[120:123], v21, s[24:27], s64 offen offset:0 sc1
    s_waitcnt lgkmcnt(0)
    v_pk_add_f32 v[184:185], v[184:185], v[208:209]
    v_pk_add_f32 v[186:187], v[186:187], v[210:211]
    v_pk_mul_f32 v[184:185], v[184:185], v[164:165]
    v_pk_mul_f32 v[186:187], v[186:187], v[166:167]
    v_cvt_pk_bf16_f32 v246, v184, v185
    buffer_load_dwordx4 v[124:127], v21, s[24:27], s65 offen offset:0 sc1
    v_cvt_pk_bf16_f32 v247, v186, v187
    v_min_u32 v246, -2, v246
    v_min_u32 v247, -2, v247
    buffer_store_dwordx4 v[244:247], v21, s[24:27], s98 offen offset:2048 sc1
    s_lshl2_add_u32 s36, s2, s32
    s_cmp_lg_u32 s36, 8
    s_cbranch_scc1 L_ep
    s_mov_b64 exec, 1
    buffer_store_dword v28, v21, s[24:27], 0 offen sc1
    s_mov_b64 exec, -1
L_ep:
    s_mov_b32 s39, 0
    s_waitcnt vmcnt(10)
    s_barrier
    buffer_load_dwordx4 v21, s[24:27], s38 offen offset:2048 sc1 lds
    ds_read_b128 a[0:3], v21 offset:0
    ds_read_b128 a[4:7], v21 offset:1024
    ds_read_b128 a[8:11], v21 offset:2048
    ds_read_b128 a[12:15], v21 offset:3072
    buffer_load_dwordx4 v21, s[24:27], s38 offen offset:3072 sc1 lds
    s_add_u32 m0, s68, 45056
    s_add_u32 s38, s66, 45056
    ds_read_b128 a[16:19], v21 offset:4096
    ds_read_b128 a[20:23], v21 offset:5120
    ds_read_b128 a[24:27], v21 offset:6144
    ds_read_b128 a[28:31], v21 offset:7168
    buffer_load_dwordx4 v21, s[24:27], s38 offen sc1 lds
    s_add_u32 m0, s68, 46080
    s_add_u32 s38, s67, 40960
    s_waitcnt lgkmcnt(3)
    v_mfma_f32_16x16x32_bf16 v[212:215], a[0:3], v[236:239], 0
    ds_read_b128 a[32:35], v21 offset:8192
    s_waitcnt vmcnt(8)
    v_max3_u32 v200, v100, v102, v104
    ds_read_b128 a[36:39], v21 offset:9216
    buffer_load_dwordx4 v21, s[24:27], s38 offen sc1 lds
    v_mfma_f32_16x16x32_bf16 v[216:219], a[4:7], v[236:239], 0
    ds_read_b128 a[40:43], v21 offset:10240
    v_max3_u32 v200, v200, v106, v108
    ds_read_b128 a[44:47], v21 offset:11264
    v_mfma_f32_16x16x32_bf16 v[220:223], a[8:11], v[236:239], 0
    buffer_load_dwordx4 v21, s[24:27], s38 offen offset:1024 sc1 lds
    v_max_u32 v200, v200, v110
    ds_read_b128 a[48:51], v21 offset:12288
    v_mfma_f32_16x16x32_bf16 v[224:227], a[12:15], v[236:239], 0
    ds_read_b128 a[52:55], v21 offset:13312
    v_cmp_eq_u32 vcc, -1, v200
    s_cmp_lg_u64 vcc, 0
    s_cbranch_scc1 L_hs1
L_hk1:
    buffer_load_dwordx4 v21, s[24:27], s38 offen offset:2048 sc1 lds
    ds_read_b128 a[56:59], v21 offset:14336
    v_mfma_f32_16x16x32_bf16 v[228:231], a[16:19], v[236:239], 0
    ds_read_b128 a[60:63], v21 offset:15360
    s_waitcnt lgkmcnt(6)
    v_mfma_f32_16x16x32_bf16 v[212:215], a[20:23], v[100:103], v[212:215]
    buffer_load_dwordx4 v21, s[24:27], s38 offen offset:3072 sc1 lds
    s_add_u32 m0, s68, 50176
    s_add_u32 s38, s67, 45056
    ds_read_b128 a[64:67], v21 offset:16384
    v_mfma_f32_16x16x32_bf16 v[216:219], a[24:27], v[100:103], v[216:219]
    v_mfma_f32_16x16x32_bf16 v[220:223], a[28:31], v[100:103], v[220:223]
    ds_read_b128 a[68:71], v21 offset:17408
    v_mfma_f32_16x16x32_bf16 v[224:227], a[32:35], v[100:103], v[224:227]
    ds_read_b128 a[72:75], v21 offset:18432
    buffer_load_dwordx4 v21, s[24:27], s38 offen sc1 lds
    s_add_u32 m0, s68, 81920
    s_add_u32 s38, s66, 81920
    v_mfma_f32_16x16x32_bf16 v[228:231], a[36:39], v[100:103], v[228:231]
    ds_read_b128 a[76:79], v21 offset:19456
    s_waitcnt lgkmcnt(5)
    v_mfma_f32_16x16x32_bf16 v[212:215], a[40:43], v[104:107], v[212:215]
    ds_read_b128 a[80:83], v21 offset:20480
    buffer_load_dwordx4 v[32:35], v21, s[24:27], s59 offen offset:1024 sc1
    v_mfma_f32_16x16x32_bf16 v[216:219], a[44:47], v[104:107], v[216:219]
    v_mfma_f32_16x16x32_bf16 v[220:223], a[48:51], v[104:107], v[220:223]
    ds_read_b128 a[84:87], v21 offset:21504
    v_mfma_f32_16x16x32_bf16 v[224:227], a[52:55], v[104:107], v[224:227]
    ds_read_b128 a[88:91], v21 offset:22528
    v_mfma_f32_16x16x32_bf16 v[228:231], a[56:59], v[104:107], v[228:231]
    buffer_load_dwordx4 v[36:39], v21, s[24:27], s60 offen offset:1024 sc1
    ds_read_b128 a[92:95], v21 offset:23552
    s_waitcnt lgkmcnt(4)
    v_mfma_f32_16x16x32_bf16 v[212:215], a[60:63], v[108:111], v[212:215]
    ds_read_b128 a[96:99], v21 offset:24576
    s_waitcnt vmcnt(11)
    v_max3_u32 v200, v112, v114, v116
    buffer_load_dwordx4 v[40:43], v21, s[24:27], s61 offen offset:1024 sc1
    ds_read_b128 a[100:103], v21 offset:25600
    v_mfma_f32_16x16x32_bf16 v[216:219], a[64:67], v[108:111], v[216:219]
    v_max3_u32 v200, v200, v118, v120
    ds_read_b128 a[104:107], v21 offset:26624
    v_mfma_f32_16x16x32_bf16 v[220:223], a[68:71], v[108:111], v[220:223]
    ds_read_b128 a[108:111], v21 offset:27648
    buffer_load_dwordx4 v[44:47], v21, s[24:27], s62 offen offset:1024 sc1
    v_max3_u32 v200, v200, v122, v124
    ds_read_b128 a[112:115], v21 offset:28672
    v_mfma_f32_16x16x32_bf16 v[224:227], a[72:75], v[108:111], v[224:227]
    ds_read_b128 a[116:119], v21 offset:29696
    v_max_u32 v200, v200, v126
    buffer_load_dwordx4 v[48:51], v21, s[24:27], s63 offen offset:1024 sc1
    v_mfma_f32_16x16x32_bf16 v[228:231], a[76:79], v[108:111], v[228:231]
    ds_read_b128 a[120:123], v21 offset:30720
    v_cmp_eq_u32 vcc, -1, v200
    s_cmp_lg_u64 vcc, 0
    s_cbranch_scc1 L_hs4
L_hk4:
    ds_read_b128 a[124:127], v21 offset:31744
    buffer_load_dwordx4 v[52:55], v21, s[24:27], s64 offen offset:1024 sc1
    s_waitcnt lgkmcnt(7)
    v_mfma_f32_16x16x32_bf16 v[212:215], a[80:83], v[112:115], v[212:215]
    ds_read_b128 a[128:131], v21 offset:32768
    v_mfma_f32_16x16x32_bf16 v[216:219], a[84:87], v[112:115], v[216:219]
    ds_read_b128 a[132:135], v21 offset:33792
    v_mfma_f32_16x16x32_bf16 v[220:223], a[88:91], v[112:115], v[220:223]
    buffer_load_dwordx4 v[56:59], v21, s[24:27], s65 offen offset:1024 sc1
    ds_read_b128 a[136:139], v21 offset:34816
    v_mfma_f32_16x16x32_bf16 v[224:227], a[92:95], v[112:115], v[224:227]
    v_mfma_f32_16x16x32_bf16 v[228:231], a[96:99], v[112:115], v[228:231]
    ds_read_b128 a[140:143], v21 offset:35840
    s_waitcnt lgkmcnt(6)
    v_mfma_f32_16x16x32_bf16 v[212:215], a[100:103], v[116:119], v[212:215]
    buffer_load_dwordx4 v21, s[24:27], s38 offen sc1 lds
    ds_read_b128 a[144:147], v21 offset:36864
    v_mfma_f32_16x16x32_bf16 v[216:219], a[104:107], v[116:119], v[216:219]
    ds_read_b128 a[148:151], v21 offset:37888
    v_mfma_f32_16x16x32_bf16 v[220:223], a[108:111], v[116:119], v[220:223]
    ds_read_b128 a[152:155], v21 offset:38912
    buffer_load_dwordx4 v21, s[24:27], s38 offen offset:1024 sc1 lds
    v_mfma_f32_16x16x32_bf16 v[224:227], a[112:115], v[116:119], v[224:227]
    v_mfma_f32_16x16x32_bf16 v[228:231], a[116:119], v[116:119], v[228:231]
    ds_read_b128 a[156:159], v21 offset:39936
    s_waitcnt lgkmcnt(5)
    v_mfma_f32_16x16x32_bf16 v[212:215], a[120:123], v[120:123], v[212:215]
    v_mfma_f32_16x16x32_bf16 v[216:219], a[124:127], v[120:123], v[216:219]
    v_mfma_f32_16x16x32_bf16 v[220:223], a[128:131], v[120:123], v[220:223]
    buffer_load_dwordx4 v21, s[24:27], s38 offen offset:2048 sc1 lds
    v_mfma_f32_16x16x32_bf16 v[224:227], a[132:135], v[120:123], v[224:227]
    v_mfma_f32_16x16x32_bf16 v[228:231], a[136:139], v[120:123], v[228:231]
    s_waitcnt lgkmcnt(0)
    v_mfma_f32_16x16x32_bf16 v[212:215], a[140:143], v[124:127], v[212:215]
    v_mfma_f32_16x16x32_bf16 v[216:219], a[144:147], v[124:127], v[216:219]
    v_mfma_f32_16x16x32_bf16 v[220:223], a[148:151], v[124:127], v[220:223]
    v_mfma_f32_16x16x32_bf16 v[224:227], a[152:155], v[124:127], v[224:227]
    v_mfma_f32_16x16x32_bf16 v[228:231], a[156:159], v[124:127], v[228:231]
    s_waitcnt vmcnt(10)
    s_barrier
    buffer_load_dwordx4 v21, s[24:27], s38 offen offset:3072 sc1 lds
    s_add_u32 m0, s68, 86016
    s_add_u32 s38, s66, 86016
    ds_read_b128 a[160:163], v21 offset:40960
    ds_read_b128 a[164:167], v21 offset:41984
    ds_read_b128 a[168:171], v21 offset:43008
    ds_read_b128 a[172:175], v21 offset:44032
    ds_read_b128 a[176:179], v21 offset:45056
    ds_read_b128 a[180:183], v21 offset:46080
    buffer_load_dwordx4 v21, s[24:27], s38 offen sc1 lds
    s_add_u32 m0, s68, 87040
    s_add_u32 s38, s67, 81920
    ds_read_b128 a[184:187], v21 offset:47104
    ds_read_b128 a[188:191], v21 offset:48128
    s_waitcnt lgkmcnt(3)
    v_mfma_f32_16x16x32_bf16 v[212:215], a[160:163], v[240:243], v[212:215]
    ds_read_b128 a[192:195], v21 offset:49152
    s_waitcnt vmcnt(9)
    v_max3_u32 v200, v32, v34, v36
    buffer_load_dwordx4 v21, s[24:27], s38 offen sc1 lds
    ds_read_b128 a[196:199], v21 offset:50176
    v_mfma_f32_16x16x32_bf16 v[216:219], a[164:167], v[240:243], v[216:219]
    ds_read_b128 a[200:203], v21 offset:51200
    v_max3_u32 v200, v200, v38, v40
    ds_read_b128 a[204:207], v21 offset:52224
    v_mfma_f32_16x16x32_bf16 v[220:223], a[168:171], v[240:243], v[220:223]
    buffer_load_dwordx4 v21, s[24:27], s38 offen offset:1024 sc1 lds
    v_max_u32 v200, v200, v42
    ds_read_b128 a[208:211], v21 offset:53248
    v_mfma_f32_16x16x32_bf16 v[224:227], a[172:175], v[240:243], v[224:227]
    ds_read_b128 a[212:215], v21 offset:54272
    v_cmp_eq_u32 vcc, -1, v200
    s_cmp_lg_u64 vcc, 0
    s_cbranch_scc1 L_hs9
L_hk9:
    ds_read_b128 a[216:219], v21 offset:55296
    buffer_load_dwordx4 v21, s[24:27], s38 offen offset:2048 sc1 lds
    v_mfma_f32_16x16x32_bf16 v[228:231], a[176:179], v[240:243], v[228:231]
    ds_read_b128 a[220:223], v21 offset:56320
    s_waitcnt lgkmcnt(6)
    v_mfma_f32_16x16x32_bf16 v[212:215], a[180:183], v[32:35], v[212:215]
    ds_read_b128 a[224:227], v21 offset:57344
    v_mfma_f32_16x16x32_bf16 v[216:219], a[184:187], v[32:35], v[216:219]
    v_mfma_f32_16x16x32_bf16 v[220:223], a[188:191], v[32:35], v[220:223]
    buffer_load_dwordx4 v21, s[24:27], s38 offen offset:3072 sc1 lds
    s_add_u32 m0, s68, 91136
    s_add_u32 s38, s67, 86016
    ds_read_b128 a[228:231], v21 offset:58368
    v_mfma_f32_16x16x32_bf16 v[224:227], a[192:195], v[32:35], v[224:227]
    ds_read_b128 a[232:235], v21 offset:59392
    v_mfma_f32_16x16x32_bf16 v[228:231], a[196:199], v[32:35], v[228:231]
    ds_read_b128 a[236:239], v21 offset:60416
    s_waitcnt lgkmcnt(5)
    v_mfma_f32_16x16x32_bf16 v[212:215], a[200:203], v[36:39], v[212:215]
    ds_read_b128 a[0:3], v9 offset:0
    buffer_load_dwordx4 v21, s[24:27], s38 offen sc1 lds
    v_mfma_f32_16x16x32_bf16 v[216:219], a[204:207], v[36:39], v[216:219]
    v_mfma_f32_16x16x32_bf16 v[220:223], a[208:211], v[36:39], v[220:223]
    ds_read_b128 a[4:7], v9 offset:1024
    v_mfma_f32_16x16x32_bf16 v[224:227], a[212:215], v[36:39], v[224:227]
    ds_read_b128 a[8:11], v9 offset:2048
    v_mfma_f32_16x16x32_bf16 v[228:231], a[216:219], v[36:39], v[228:231]
    ds_read_b128 a[12:15], v9 offset:3072
    buffer_load_dwordx4 v[60:63], v21, s[24:27], s59 offen offset:2048 sc1
    s_waitcnt lgkmcnt(4)
    v_mfma_f32_16x16x32_bf16 v[212:215], a[220:223], v[40:43], v[212:215]
    ds_read_b128 a[16:19], v9 offset:4096
    s_waitcnt vmcnt(11)
    v_max3_u32 v200, v44, v46, v48
    ds_read_b128 a[20:23], v9 offset:5120
    v_mfma_f32_16x16x32_bf16 v[216:219], a[224:227], v[40:43], v[216:219]
    v_max3_u32 v200, v200, v50, v52
    buffer_load_dwordx4 v[64:67], v21, s[24:27], s60 offen offset:2048 sc1
    ds_read_b128 a[24:27], v9 offset:6144
    v_mfma_f32_16x16x32_bf16 v[220:223], a[228:231], v[40:43], v[220:223]
    ds_read_b128 a[28:31], v9 offset:7168
    v_max3_u32 v200, v200, v54, v56
    ds_read_b128 a[32:35], v9 offset:8192
    v_mfma_f32_16x16x32_bf16 v[224:227], a[232:235], v[40:43], v[224:227]
    buffer_load_dwordx4 v[68:71], v21, s[24:27], s61 offen offset:2048 sc1
    ds_read_b128 a[36:39], v9 offset:9216
    v_max_u32 v200, v200, v58
    v_mfma_f32_16x16x32_bf16 v[228:231], a[236:239], v[40:43], v[228:231]
    ds_read_b128 a[40:43], v9 offset:10240
    v_cmp_eq_u32 vcc, -1, v200
    s_cmp_lg_u64 vcc, 0
    s_cbranch_scc1 L_hs12
L_hk12:
    ds_read_b128 a[44:47], v9 offset:11264
    buffer_load_dwordx4 v[72:75], v21, s[24:27], s62 offen offset:2048 sc1
    s_waitcnt lgkmcnt(7)
    v_mfma_f32_16x16x32_bf16 v[212:215], a[0:3], v[44:47], v[212:215]
    ds_read_b128 a[48:51], v9 offset:12288
    v_mfma_f32_16x16x32_bf16 v[216:219], a[4:7], v[44:47], v[216:219]
    ds_read_b128 a[52:55], v9 offset:13312
    v_mfma_f32_16x16x32_bf16 v[220:223], a[8:11], v[44:47], v[220:223]
    ds_read_b128 a[56:59], v9 offset:14336
    buffer_load_dwordx4 v[76:79], v21, s[24:27], s63 offen offset:2048 sc1
    v_mfma_f32_16x16x32_bf16 v[224:227], a[12:15], v[44:47], v[224:227]
    v_mfma_f32_16x16x32_bf16 v[228:231], a[16:19], v[44:47], v[228:231]
    ds_read_b128 a[60:63], v9 offset:15360
    s_waitcnt lgkmcnt(6)
    v_mfma_f32_16x16x32_bf16 v[212:215], a[20:23], v[48:51], v[212:215]
    ds_read_b128 a[64:67], v9 offset:16384
    v_mfma_f32_16x16x32_bf16 v[216:219], a[24:27], v[48:51], v[216:219]
    ds_read_b128 a[68:71], v9 offset:17408
    buffer_load_dwordx4 v[80:83], v21, s[24:27], s64 offen offset:2048 sc1
    v_mfma_f32_16x16x32_bf16 v[220:223], a[28:31], v[48:51], v[220:223]
    ds_read_b128 a[72:75], v9 offset:18432
    v_mfma_f32_16x16x32_bf16 v[224:227], a[32:35], v[48:51], v[224:227]
    v_mfma_f32_16x16x32_bf16 v[228:231], a[36:39], v[48:51], v[228:231]
    ds_read_b128 a[76:79], v9 offset:19456
    s_waitcnt lgkmcnt(5)
    v_mfma_f32_16x16x32_bf16 v[212:215], a[40:43], v[52:55], v[212:215]
    v_mfma_f32_16x16x32_bf16 v[216:219], a[44:47], v[52:55], v[216:219]
    buffer_load_dwordx4 v[84:87], v21, s[24:27], s65 offen offset:2048 sc1
    v_mfma_f32_16x16x32_bf16 v[220:223], a[48:51], v[52:55], v[220:223]
    v_mfma_f32_16x16x32_bf16 v[224:227], a[52:55], v[52:55], v[224:227]
    v_mfma_f32_16x16x32_bf16 v[228:231], a[56:59], v[52:55], v[228:231]
    s_waitcnt lgkmcnt(0)
    v_mfma_f32_16x16x32_bf16 v[212:215], a[60:63], v[56:59], v[212:215]
    v_mfma_f32_16x16x32_bf16 v[216:219], a[64:67], v[56:59], v[216:219]
    v_mfma_f32_16x16x32_bf16 v[220:223], a[68:71], v[56:59], v[220:223]
    v_mfma_f32_16x16x32_bf16 v[224:227], a[72:75], v[56:59], v[224:227]
    v_mfma_f32_16x16x32_bf16 v[228:231], a[76:79], v[56:59], v[228:231]
    s_waitcnt vmcnt(7)
    s_barrier
    ds_read_b128 a[80:83], v9 offset:20480
    ds_read_b128 a[84:87], v9 offset:21504
    ds_read_b128 a[88:91], v9 offset:22528
    ds_read_b128 a[92:95], v9 offset:23552
    ds_read_b128 a[96:99], v9 offset:24576
    ds_read_b128 a[100:103], v9 offset:25600
    ds_read_b128 a[104:107], v9 offset:26624
    ds_read_b128 a[108:111], v9 offset:27648
    ds_read_b128 a[112:115], v9 offset:28672
    s_waitcnt lgkmcnt(4)
    v_mfma_f32_16x16x32_bf16 v[212:215], a[80:83], v[244:247], v[212:215]
    ds_read_b128 a[116:119], v9 offset:29696
    s_waitcnt vmcnt(5)
    v_max3_u32 v200, v60, v62, v64
    ds_read_b128 a[120:123], v9 offset:30720
    v_mfma_f32_16x16x32_bf16 v[216:219], a[84:87], v[244:247], v[216:219]
    ds_read_b128 a[124:127], v9 offset:31744
    v_mfma_f32_16x16x32_bf16 v[220:223], a[88:91], v[244:247], v[220:223]
    ds_read_b128 a[128:131], v9 offset:32768
    v_max_u32 v200, v200, v66
    ds_read_b128 a[132:135], v9 offset:33792
    v_mfma_f32_16x16x32_bf16 v[224:227], a[92:95], v[244:247], v[224:227]
    ds_read_b128 a[136:139], v9 offset:34816
    v_cmp_eq_u32 vcc, -1, v200
    s_cmp_lg_u64 vcc, 0
    s_cbranch_scc1 L_hs17
L_hk17:
    ds_read_b128 a[140:143], v9 offset:35840
    ds_read_b128 a[144:147], v9 offset:36864
    v_mfma_f32_16x16x32_bf16 v[228:231], a[96:99], v[244:247], v[228:231]
    ds_read_b128 a[148:151], v9 offset:37888
    s_waitcnt lgkmcnt(8)
    v_mfma_f32_16x16x32_bf16 v[212:215], a[100:103], v[60:63], v[212:215]
    ds_read_b128 a[152:155], v9 offset:38912
    v_mfma_f32_16x16x32_bf16 v[216:219], a[104:107], v[60:63], v[216:219]
    ds_read_b128 a[156:159], v9 offset:39936
    v_mfma_f32_16x16x32_bf16 v[220:223], a[108:111], v[60:63], v[220:223]
    ds_read_b128 a[160:163], v9 offset:40960
    v_mfma_f32_16x16x32_bf16 v[224:227], a[112:115], v[60:63], v[224:227]
    ds_read_b128 a[164:167], v9 offset:41984
    v_mfma_f32_16x16x32_bf16 v[228:231], a[116:119], v[60:63], v[228:231]
    ds_read_b128 a[168:171], v9 offset:43008
    s_waitcnt lgkmcnt(8)
    v_mfma_f32_16x16x32_bf16 v[212:215], a[120:123], v[64:67], v[212:215]
    ds_read_b128 a[172:175], v9 offset:44032
    ds_read_b128 a[176:179], v9 offset:45056
    s_waitcnt vmcnt(3)
    v_max3_u32 v200, v68, v70, v72
    ds_read_b128 a[180:183], v9 offset:46080
    v_mfma_f32_16x16x32_bf16 v[216:219], a[124:127], v[64:67], v[216:219]
    ds_read_b128 a[184:187], v9 offset:47104
    v_mfma_f32_16x16x32_bf16 v[220:223], a[128:131], v[64:67], v[220:223]
    ds_read_b128 a[188:191], v9 offset:48128
    v_max_u32 v200, v200, v74
    ds_read_b128 a[192:195], v9 offset:49152
    v_mfma_f32_16x16x32_bf16 v[224:227], a[132:135], v[64:67], v[224:227]
    ds_read_b128 a[196:199], v9 offset:50176
    v_cmp_eq_u32 vcc, -1, v200
    s_cmp_lg_u64 vcc, 0
    s_cbranch_scc1 L_hs19
L_hk19:
    ds_read_b128 a[200:203], v9 offset:51200
    v_mfma_f32_16x16x32_bf16 v[228:231], a[136:139], v[64:67], v[228:231]
    ds_read_b128 a[204:207], v9 offset:52224
    ds_read_b128 a[208:211], v9 offset:53248
    s_waitcnt lgkmcnt(13)
    v_mfma_f32_16x16x32_bf16 v[212:215], a[140:143], v[68:71], v[212:215]
    ds_read_b128 a[212:215], v9 offset:54272
    v_mfma_f32_16x16x32_bf16 v[216:219], a[144:147], v[68:71], v[216:219]
    ds_read_b128 a[216:219], v9 offset:55296
    v_mfma_f32_16x16x32_bf16 v[220:223], a[148:151], v[68:71], v[220:223]
    ds_read_b128 a[220:223], v9 offset:56320
    v_mfma_f32_16x16x32_bf16 v[224:227], a[152:155], v[68:71], v[224:227]
    ds_read_b128 a[224:227], v9 offset:57344
    v_mfma_f32_16x16x32_bf16 v[228:231], a[156:159], v[68:71], v[228:231]
    ds_read_b128 a[228:231], v9 offset:58368
    s_waitcnt lgkmcnt(13)
    v_mfma_f32_16x16x32_bf16 v[212:215], a[160:163], v[72:75], v[212:215]
    ds_read_b128 a[232:235], v9 offset:59392
    s_waitcnt vmcnt(0)
    v_max3_u32 v200, v76, v78, v80
    ds_read_b128 a[236:239], v9 offset:60416
    v_mfma_f32_16x16x32_bf16 v[216:219], a[164:167], v[72:75], v[216:219]
    v_max3_u32 v200, v200, v82, v84
    v_mfma_f32_16x16x32_bf16 v[220:223], a[168:171], v[72:75], v[220:223]
    v_max_u32 v200, v200, v86
    v_mfma_f32_16x16x32_bf16 v[224:227], a[172:175], v[72:75], v[224:227]
    v_cmp_eq_u32 vcc, -1, v200
    s_cmp_lg_u64 vcc, 0
    s_cbranch_scc1 L_hs21
L_hk21:
    v_mfma_f32_16x16x32_bf16 v[228:231], a[176:179], v[72:75], v[228:231]
    s_waitcnt lgkmcnt(0)
    v_mfma_f32_16x16x32_bf16 v[212:215], a[180:183], v[76:79], v[212:215]
    v_mfma_f32_16x16x32_bf16 v[212:215], a[200:203], v[80:83], v[212:215]
    v_mfma_f32_16x16x32_bf16 v[212:215], a[220:223], v[84:87], v[212:215]
    v_mfma_f32_16x16x32_bf16 v[216:219], a[184:187], v[76:79], v[216:219]
    v_mfma_f32_16x16x32_bf16 v[216:219], a[204:207], v[80:83], v[216:219]
    v_mfma_f32_16x16x32_bf16 v[216:219], a[224:227], v[84:87], v[216:219]
    v_mfma_f32_16x16x32_bf16 v[220:223], a[188:191], v[76:79], v[220:223]
    s_nop 3
    v_cvt_pk_bf16_f32 v168, v212, v213
    v_cvt_pk_bf16_f32 v169, v214, v215
    v_mfma_f32_16x16x32_bf16 v[220:223], a[208:211], v[80:83], v[220:223]
    ds_write_b64 v11, v[168:169] offset:0
    v_mfma_f32_16x16x32_bf16 v[220:223], a[228:231], v[84:87], v[220:223]
    v_mfma_f32_16x16x32_bf16 v[224:227], a[192:195], v[76:79], v[224:227]
    v_cvt_pk_bf16_f32 v170, v216, v217
    v_cvt_pk_bf16_f32 v171, v218, v219
    v_mfma_f32_16x16x32_bf16 v[224:227], a[212:215], v[80:83], v[224:227]
    ds_write_b64 v11, v[170:171] offset:32
    v_mfma_f32_16x16x32_bf16 v[224:227], a[232:235], v[84:87], v[224:227]
    v_mfma_f32_16x16x32_bf16 v[228:231], a[196:199], v[76:79], v[228:231]
    s_nop 0
    v_cvt_pk_bf16_f32 v172, v220, v221
    v_cvt_pk_bf16_f32 v173, v222, v223
    v_mfma_f32_16x16x32_bf16 v[228:231], a[216:219], v[80:83], v[228:231]
    ds_write_b64 v11, v[172:173] offset:64
    v_mfma_f32_16x16x32_bf16 v[228:231], a[236:239], v[84:87], v[228:231]
    s_nop 0
    v_cvt_pk_bf16_f32 v174, v224, v225
    v_cvt_pk_bf16_f32 v175, v226, v227
    ds_write_b64 v11, v[174:175] offset:96
    s_nop 3
    v_cvt_pk_bf16_f32 v176, v228, v229
    v_cvt_pk_bf16_f32 v177, v230, v231
    ds_write_b64 v11, v[176:177] offset:128
    s_waitcnt lgkmcnt(0)
    ds_read_b128 v[180:183], v12
    ds_read_b128 v[184:187], v13
    ds_read_b128 v[188:191], v14
    s_waitcnt lgkmcnt(2)
    buffer_store_dwordx4 v[180:183], v4, s[20:23], s69 offen
    s_waitcnt lgkmcnt(1)
    buffer_store_dwordx4 v[184:187], v5, s[20:23], s69 offen
    s_mov_b32 exec_hi, 0
    s_waitcnt lgkmcnt(0)
    buffer_store_dwordx4 v[188:191], v6, s[20:23], s69 offen
L_end:
    s_endpgm
L_helper:
    s_mov_b32 s14, 8388608
    s_mov_b32 s15, 0x20000
    s_mov_b32 s22, 2621440
    s_mov_b32 s23, 0x20000
    s_mov_b32 s26, 10485760
    s_mov_b32 s27, 0x20000
    s_mov_b32 s30, 4096
    s_mov_b32 s31, 0x20000
    v_and_b32 v241, 15, v0
    v_lshrrev_b32 v2, 1, v241
    v_xor_b32 v2, v2, v240
    v_lshlrev_b32 v2, 4, v2
    v_lshl_add_u32 v2, v241, 7, v2
    v_add_u32 v6, s40, v2
    v_xor_b32 v7, 64, v6
    v_bfe_u32 v243, v0, 2, 2
    v_and_b32 v244, 3, v0
    v_and_b32 v242, 1, v240
    v_lshl_add_u32 v246, v240, 3, v243
    v_lshrrev_b32 v247, 2, v0
    s_lshl_b32 s54, s32, 5
    v_lshl_add_u32 v1, v244, 3, s54
    v_lshl_add_u32 v246, v246, 7, v1
    v_lshl_add_u32 v247, v247, 7, v1
    s_lshl4_add_u32 s60, s59, s32
    s_lshl_b32 s60, s60, 10
    s_lshl_b32 s61, s61, 7
    s_add_u32 s61, s61, 65536
    s_cmp_lt_u32 s59, 60
    s_cselect_b32 s60, s60, 10485760
    s_cselect_b32 s61, s61, 10485760
    s_lshl1_add_u32 s54, s101, s95
    s_mul_i32 s54, s54, 12288
    s_add_u32 s100, s54, 4194304
    s_waitcnt lgkmcnt(0)
    s_mul_i32 s35, s35, 1664525
    s_add_u32 s35, s35, 1013904223
    v_mov_b32 v28, s35
    v_mov_b32 v29, s35
    v_mov_b32 v30, s35
    v_mov_b32 v31, s35
    s_lshl3_add_u32 s54, s101, s34
    s_mul_i32 s54, s54, 3072
    s_add_u32 s98, s54, 4194304
    v_mov_b32 v152, -1
    v_mov_b32 v153, -1
    v_mov_b32 v154, -1
    v_mov_b32 v155, -1
    s_mov_b64 exec, 0
    s_cmp_eq_u32 s32, 0
    s_cbranch_scc1 L_page5
    s_cmp_eq_u32 s32, 1
    s_cbranch_scc1 L_page6
    s_cmp_eq_u32 s32, 2
    s_cbranch_scc1 L_page7
    s_cmp_eq_u32 s32, 3
    s_cbranch_scc1 L_ret1
L_hret1:
    s_mov_b64 exec, -1
    s_mov_b64 exec, 0
    s_cmp_eq_u32 s32, 0
    s_cbranch_scc1 L_page1
    s_cmp_eq_u32 s32, 1
    s_cbranch_scc1 L_page2
    s_cmp_eq_u32 s32, 2
    s_cbranch_scc1 L_page3
    s_cmp_eq_u32 s32, 3
    s_cbranch_scc1 L_page4
L_hret0:
    s_mov_b64 exec, -1
    s_add_u32 m0, s40, 0
    s_nop 0
    buffer_load_dwordx4 v4, s[4:7], s52 offen lds
    s_lshl_b32 s54, s33, 18
    s_lshl_b32 s55, s32, 10
    s_add_u32 s54, s54, s55
    v_lshlrev_b32 v2, 12, v3
    v_add3_u32 v13, v2, v13, s54
    s_add_u32 s54, s54, 31744
    v_add3_u32 v14, v2, v14, s54
    buffer_load_dwordx4 v5, s[4:7], s52 offen offset:1024 lds
    s_add_u32 m0, s40, 2048
    s_add_u32 s52, s52, 128
    s_cmp_eq_u32 s52, 1280
    s_cselect_b32 s52, 0, s52
    s_mul_i32 s54, s92, 1
    s_lshl2_add_u32 s54, s95, s54
    s_add_u32 s55, s54, 0
    s_and_b32 s55, s55, 7
    s_lshl_b32 s72, s55, 11
    s_lshl_b32 s80, s55, 7
    s_add_u32 s55, s54, 1
    buffer_load_dwordx4 v4, s[4:7], s52 offen lds
    s_and_b32 s55, s55, 7
    s_lshl_b32 s73, s55, 11
    s_lshl_b32 s81, s55, 7
    s_add_u32 s55, s54, 2
    s_and_b32 s55, s55, 7
    s_lshl_b32 s74, s55, 11
    s_lshl_b32 s82, s55, 7
    buffer_load_dwordx4 v5, s[4:7], s52 offen offset:1024 lds
    s_add_u32 m0, s40, 4096
    s_add_u32 s52, s52, 128
    s_cmp_eq_u32 s52, 1280
    s_cselect_b32 s52, 0, s52
    s_add_u32 s55, s54, 3
    s_and_b32 s55, s55, 7
    s_lshl_b32 s75, s55, 11
    s_lshl_b32 s83, s55, 7
    s_add_u32 s55, s54, 4
    s_and_b32 s55, s55, 7
    s_lshl_b32 s76, s55, 11
    buffer_load_dwordx4 v4, s[4:7], s52 offen lds
    s_lshl_b32 s84, s55, 7
    s_add_u32 s55, s54, 5
    s_and_b32 s55, s55, 7
    s_lshl_b32 s77, s55, 11
    s_lshl_b32 s85, s55, 7
    s_add_u32 s55, s54, 6
    s_and_b32 s55, s55, 7
    buffer_load_dwordx4 v5, s[4:7], s52 offen offset:1024 lds
    s_add_u32 m0, s40, 6144
    s_add_u32 s52, s52, 128
    s_cmp_eq_u32 s52, 1280
    s_cselect_b32 s52, 0, s52
    s_lshl_b32 s78, s55, 11
    s_lshl_b32 s86, s55, 7
    s_add_u32 s55, s54, 7
    s_and_b32 s55, s55, 7
    s_lshl_b32 s79, s55, 11
    s_lshl_b32 s87, s55, 7
    s_add_u32 s55, s32, 0
    buffer_load_dwordx4 v4, s[4:7], s52 offen lds
    s_and_b32 s55, s55, 3
    s_lshl_b32 s88, s55, 16
    s_mul_i32 s55, s55, 3072
    s_add_u32 s55, s55, 122880
    v_add_u32 v26, s55, v21
    s_add_u32 s55, s32, 1
    s_and_b32 s55, s55, 3
    buffer_load_dwordx4 v5, s[4:7], s52 offen offset:1024 lds
    s_lshl_b32 s89, s55, 16
    s_mul_i32 s55, s55, 3072
    s_add_u32 s55, s55, 122880
    v_add_u32 v23, s55, v21
    s_add_u32 s55, s32, 2
    s_and_b32 s55, s55, 3
    s_lshl_b32 s90, s55, 16
    s_waitcnt vmcnt(8)
    s_barrier
    ds_read_b64_tr_b16 v[168:169], v246 offset:0
    ds_read_b64_tr_b16 v[170:171], v246 offset:512
    ds_read_b64_tr_b16 v[172:173], v246 offset:4096
    ds_read_b64_tr_b16 v[174:175], v246 offset:4608
    ds_read_b64_tr_b16 v[176:177], v246 offset:8192
    ds_read_b64_tr_b16 v[178:179], v246 offset:8704
    ds_read_b64_tr_b16 v[180:181], v246 offset:12288
    ds_read_b64_tr_b16 v[182:183], v246 offset:12800
    ds_read_b64_tr_b16 v[184:185], v247 offset:16384
    ds_read_b64_tr_b16 v[186:187], v247 offset:18432
    ds_read_b64_tr_b16 v[188:189], v247 offset:20480
    ds_read_b64_tr_b16 v[190:191], v247 offset:22528
    ds_read_b64_tr_b16 v[192:193], v247 offset:24576
    ds_read_b64_tr_b16 v[194:195], v247 offset:26624
    ds_read_b64_tr_b16 v[196:197], v247 offset:28672
    ds_read_b64_tr_b16 v[198:199], v247 offset:30720
    s_add_u32 s36, s60, 9437184
    s_waitcnt lgkmcnt(14)
    buffer_store_dwordx4 v[168:171], v21, s[24:27], s36 offen sc1
    s_mul_i32 s55, s55, 3072
    s_add_u32 s55, s55, 123904
    v_add_u32 v24, s55, v21
    s_add_u32 s55, s32, 3
    s_and_b32 s55, s55, 3
    s_lshl_b32 s91, s55, 16
    s_mul_i32 s55, s55, 3072
    s_add_u32 s36, s60, 9441280
    s_waitcnt lgkmcnt(12)
L_page6:
    s_cbranch_execz L_ret1
    buffer_store_dwordx4 v[172:175], v21, s[24:27], s36 offen sc1
    s_add_u32 s55, s55, 124928
    v_add_u32 v25, s55, v21
    s_lshl_b32 s54, s101, 5
    v_lshlrev_b32 v2, 1, v241
    buffer_load_ushort v16, v2, s[28:31], s54 offen
    s_mul_i32 s41, s32, 3072
    s_lshr_b32 s54, s32, 1
    s_add_u32 s36, s60, 9445376
    s_waitcnt lgkmcnt(10)
    buffer_store_dwordx4 v[176:179], v21, s[24:27], s36 offen sc1
    s_mul_i32 s55, s54, 43008
    s_add_u32 s55, s55, s41
    s_mul_i32 s56, s34, 6144
    s_add_u32 s55, s55, s56
    s_add_u32 s55, s55, 9437184
    v_add_u32 v12, s55, v21
    s_mul_i32 s55, s34, 3
    s_add_u32 s36, s60, 9449472
    s_waitcnt lgkmcnt(8)
    buffer_store_dwordx4 v[180:183], v21, s[24:27], s36 offen sc1
    s_lshr_b32 s56, s55, 1
    s_add_u32 s56, s56, s54
    s_lshr_b32 s56, s56, 2
    s_and_b32 s54, s32, 1
    s_lshl1_add_u32 s56, s56, s54
    s_mul_i32 s56, s56, 1280
    s_add_u32 s58, s56, 65536
    s_add_u32 s36, s60, 7340032
    s_waitcnt lgkmcnt(6)
    buffer_store_dwordx4 v[184:187], v21, s[24:27], s36 offen sc1
    v_lshrrev_b32 v1, 2, v0
    v_min_u32 v255, 9, v1
    v_lshlrev_b32 v255, 7, v255
    v_lshl_add_u32 v255, v244, 2, v255
    s_lshr_b32 s54, s55, 2
    s_lshl1_add_u32 s55, s55, 5
    s_lshr_b32 s55, s55, 3
    s_add_u32 s36, s60, 7344128
    s_waitcnt lgkmcnt(4)
    buffer_store_dwordx4 v[188:191], v21, s[24:27], s36 offen sc1
    s_sub_u32 s55, s55, s54
    s_lshl_b32 s55, s55, 12
    v_and_b32 v1, 7, v1
    v_lshlrev_b32 v22, 2, v244
    v_lshl_add_u32 v22, v1, 7, v22
    v_lshrrev_b32 v1, 5, v0
    v_mad_u32_u24 v22, v1, s55, v22
    s_add_u32 s36, s60, 7348224
    s_waitcnt lgkmcnt(2)
    buffer_store_dwordx4 v[192:195], v21, s[24:27], s36 offen sc1
    s_lshl2_add_u32 s54, s54, s32
    s_lshl_b32 s54, s54, 10
    s_add_u32 s97, s54, 4096
    s_mul_i32 s54, s34, 393216
    s_lshl_b32 s55, s32, 14
    s_add_u32 s55, s55, s54
    s_add_u32 s55, s55, 1048576
    s_add_u32 s36, s60, 7352320
    s_waitcnt lgkmcnt(0)
    buffer_store_dwordx4 v[196:199], v21, s[24:27], s36 offen sc1
    v_add_u32 v20, s55, v21
    v_lshl_add_u32 v15, v240, 2, v244
    v_lshlrev_b32 v15, 4, v15
    s_lshl_b32 s54, s101, 11
    s_add_u32 s54, s54, 262144
    v_lshl_add_u32 v18, v243, 8, v15
    v_add_u32 v18, s54, v18
    s_add_u32 m0, s40, 8192
    s_add_u32 s52, s52, 128
    s_cmp_eq_u32 s52, 1280
    s_cselect_b32 s52, 0, s52
    buffer_load_dwordx4 v4, s[4:7], s52 offen lds
    s_lshl_b32 s55, s34, 8
    s_add_u32 s54, s54, s55
    v_add_u32 v15, s54, v15
    s_mov_b32 s46, 0xbdd2d3e8
    s_mov_b32 s47, 0xbdd2d3e8
    v_mov_b32 v2, 0xc0135761
    v_mov_b32 v3, 0xc0135761
    buffer_load_dwordx4 v5, s[4:7], s52 offen offset:1024 lds
    s_add_u32 m0, s40, 10240
    s_add_u32 s52, s52, 128
    s_cmp_eq_u32 s52, 1280
    s_cselect_b32 s52, 0, s52
    buffer_load_dwordx4 v4, s[4:7], s52 offen lds
    buffer_load_dwordx4 v5, s[4:7], s52 offen offset:1024 lds
    s_add_u32 m0, s40, 12288
    s_add_u32 s52, s52, 128
    s_cmp_eq_u32 s52, 1280
    s_cselect_b32 s52, 0, s52
    buffer_load_dwordx4 v4, s[4:7], s52 offen lds
    buffer_load_dwordx4 v5, s[4:7], s52 offen offset:1024 lds
    s_waitcnt vmcnt(10)
    s_barrier
    s_cmp_lg_u32 s32, 0
    s_cbranch_scc1 L_f1
    s_mov_b64 exec, 0xff
    buffer_store_dwordx4 v[28:31], v21, s[24:27], s61 offen sc1
    s_mov_b64 exec, -1
L_f1:
    s_add_u32 m0, s40, 14336
    s_add_u32 s52, s52, 128
    s_cmp_eq_u32 s52, 1280
    s_cselect_b32 s52, 0, s52
    buffer_load_dwordx4 v4, s[4:7], s52 offen lds
    buffer_load_dwordx4 v5, s[4:7], s52 offen offset:1024 lds
    s_add_u32 m0, s40, 16384
    s_add_u32 s52, s52, 128
    s_cmp_eq_u32 s52, 1280
    s_cselect_b32 s52, 0, s52
    buffer_load_dwordx4 v4, s[4:7], s52 offen lds
    buffer_load_dwordx4 v5, s[4:7], s52 offen offset:1024 lds
    s_add_u32 m0, s40, 18432
    s_add_u32 s52, s52, 128
    s_cmp_eq_u32 s52, 1280
    s_cselect_b32 s52, 0, s52
    buffer_load_dwordx4 v4, s[4:7], s52 offen lds
    buffer_load_dwordx4 v5, s[4:7], s52 offen offset:1024 lds
    s_add_u32 m0, s40, 20480
    s_add_u32 s38, s80, s88
    buffer_load_dwordx4 v13, s[12:15], s38 offen lds
    buffer_load_dwordx4 v14, s[12:15], s38 offen offset:1024 lds
    s_add_u32 m0, s40, 22528
    s_add_u32 s38, s80, s89
    buffer_load_dwordx4 v13, s[12:15], s38 offen lds
    buffer_load_dwordx4 v14, s[12:15], s38 offen offset:1024 lds
    ds_read_b128 v[32:35], v6 offset:0
    ds_read_b128 v[36:39], v7 offset:0
    ds_read_b128 v[40:43], v6 offset:2048
    ds_read_b128 v[44:47], v7 offset:2048
    ds_read_b128 v[48:51], v6 offset:4096
    ds_read_b128 v[52:55], v7 offset:4096
    ds_read_b128 v[56:59], v6 offset:6144
    ds_read_b128 v[60:63], v7 offset:6144
    s_waitcnt vmcnt(14)
    ds_read_b128 v[64:67], v6 offset:8192
    ds_read_b128 v[68:71], v7 offset:8192
    s_waitcnt vmcnt(12)
    ds_read_b128 v[72:75], v6 offset:10240
    ds_read_b128 v[76:79], v7 offset:10240
    s_waitcnt vmcnt(10)
    ds_read_b128 v[80:83], v6 offset:12288
    ds_read_b128 v[84:87], v7 offset:12288
    s_waitcnt vmcnt(8)
    ds_read_b128 v[88:91], v6 offset:14336
    ds_read_b128 v[92:95], v7 offset:14336
    s_waitcnt vmcnt(6)
    ds_read_b128 v[96:99], v6 offset:16384
    ds_read_b128 v[100:103], v7 offset:16384
    s_waitcnt vmcnt(4)
    ds_read_b128 v[104:107], v6 offset:18432
    ds_read_b128 v[108:111], v7 offset:18432
    s_waitcnt lgkmcnt(0)
    s_add_u32 m0, s40, 0
    s_add_u32 s38, s80, s90
    buffer_load_dwordx4 v13, s[12:15], s38 offen lds
    buffer_load_dwordx4 v14, s[12:15], s38 offen offset:1024 lds
    s_add_u32 m0, s40, 2048
    s_add_u32 s38, s80, s91
    buffer_load_dwordx4 v13, s[12:15], s38 offen lds
    buffer_load_dwordx4 v14, s[12:15], s38 offen offset:1024 lds
    v_mov_b32 v248, 0
    v_mov_b32 v249, s35
    v_mov_b32 v250, 0
    v_mov_b32 v251, s35
    s_mov_b32 exec_lo, 0x000f000f
    s_mov_b32 exec_hi, 0x000f000f
    buffer_store_dwordx4 v[248:251], v15, s[24:27], 0 offen sc1
    s_mov_b64 exec, -1
    s_add_u32 m0, s40, 4096
    s_add_u32 s38, s81, s88
    buffer_load_dwordx4 v13, s[12:15], s38 offen lds
    buffer_load_dwordx4 v14, s[12:15], s38 offen offset:1024 lds
    s_add_u32 m0, s40, 6144
    s_add_u32 s38, s81, s89
    buffer_load_dwordx4 v13, s[12:15], s38 offen lds
    buffer_load_dwordx4 v14, s[12:15], s38 offen offset:1024 lds
    s_add_u32 m0, s40, 8192
    s_add_u32 s38, s81, s90
    buffer_load_dwordx4 v13, s[12:15], s38 offen lds
    buffer_load_dwordx4 v14, s[12:15], s38 offen offset:1024 lds
    s_add_u32 m0, s40, 10240
    s_add_u32 s38, s81, s91
    buffer_load_dwordx4 v13, s[12:15], s38 offen lds
    buffer_load_dwordx4 v14, s[12:15], s38 offen offset:1024 lds
    buffer_load_dword v17, v255, s[24:27], s58 offen sc1
    s_add_u32 m0, s40, 12288
    s_add_u32 s38, s82, s88
    buffer_load_dwordx4 v13, s[12:15], s38 offen lds
    buffer_load_dwordx4 v14, s[12:15], s38 offen offset:1024 lds
    s_add_u32 m0, s40, 14336
    s_add_u32 s38, s82, s89
    buffer_load_dwordx4 v13, s[12:15], s38 offen lds
    buffer_load_dwordx4 v14, s[12:15], s38 offen offset:1024 lds
    s_add_u32 m0, s40, 16384
    s_add_u32 s38, s82, s90
    s_waitcnt vmcnt(20)
    ds_read_b128 a[0:3], v6 offset:20480
    buffer_load_dwordx4 v13, s[12:15], s38 offen lds
    ds_read_b128 a[16:19], v7 offset:20480
    buffer_load_dwordx4 v14, s[12:15], s38 offen offset:1024 lds
    s_add_u32 m0, s40, 18432
    s_add_u32 s38, s82, s91
    s_waitcnt vmcnt(20)
    ds_read_b128 a[4:7], v6 offset:22528
    buffer_load_dwordx4 v13, s[12:15], s38 offen lds
    ds_read_b128 a[20:23], v7 offset:22528
    buffer_load_dwordx4 v14, s[12:15], s38 offen offset:1024 lds
    s_waitcnt vmcnt(8)
    s_mov_b32 s39, 0
L_h0h_chk:
    v_cmp_ne_u32 vcc, s35, v17
    s_cmp_lg_u64 vcc, 0
    s_cbranch_scc0 L_h0h_ok
    s_add_u32 s39, s39, 1
    s_cmp_lt_u32 s39, 400000
    s_cbranch_scc0 L_h0h_ok
    buffer_load_dword v17, v255, s[24:27], s58 offen sc1
    s_waitcnt vmcnt(0)
    s_branch L_h0h_chk
L_h0h_ok:
    s_barrier
    s_add_u32 m0, s41, 36864
    s_nop 0
    buffer_load_dwordx4 v12, s[24:27], s57 offen sc1 lds
    buffer_load_dwordx4 v12, s[24:27], s57 offen offset:1024 sc1 lds
    buffer_load_dwordx4 v12, s[24:27], s57 offen offset:2048 sc1 lds
    s_add_u32 m0, s41, 49152
    s_add_u32 s57, s57, 98304
    s_cmp_eq_u32 s57, 983040
    s_cselect_b32 s57, 0, s57
    buffer_load_dwordx4 v12, s[24:27], s57 offen sc1 lds
    buffer_load_dwordx4 v12, s[24:27], s57 offen offset:1024 sc1 lds
    buffer_load_dwordx4 v12, s[24:27], s57 offen offset:2048 sc1 lds
    s_add_u32 m0, s41, 0
    s_add_u32 s57, s57, 98304
    s_cmp_eq_u32 s57, 983040
    s_cselect_b32 s57, 0, s57
    buffer_load_dwordx4 v12, s[24:27], s57 offen sc1 lds
    buffer_load_dwordx4 v12, s[24:27], s57 offen offset:1024 sc1 lds
    buffer_load_dwordx4 v12, s[24:27], s57 offen offset:2048 sc1 lds
    ds_read_b128 a[8:11], v6 offset:0
    s_add_u32 m0, s40, 20480
    s_add_u32 s38, s83, s88
    s_waitcnt lgkmcnt(3)
    buffer_load_dwordx4 v13, s[12:15], s38 offen lds
    ds_read_b128 a[24:27], v7 offset:0
    buffer_load_dwordx4 v14, s[12:15], s38 offen offset:1024 lds
    s_add_u32 m0, s40, 22528
    s_add_u32 s38, s83, s89
    ds_read_b128 a[12:15], v6 offset:2048
    s_waitcnt lgkmcnt(3)
    buffer_load_dwordx4 v13, s[12:15], s38 offen lds
    ds_read_b128 a[28:31], v7 offset:2048
    buffer_load_dwordx4 v14, s[12:15], s38 offen offset:1024 lds
    s_add_u32 m0, s40, 0
    s_add_u32 s38, s83, s90
    ds_read_b128 a[32:35], v6 offset:4096
    s_waitcnt lgkmcnt(3)
    buffer_load_dwordx4 v13, s[12:15], s38 offen lds
    ds_read_b128 a[48:51], v7 offset:4096
    buffer_load_dwordx4 v14, s[12:15], s38 offen offset:1024 lds
    s_add_u32 m0, s40, 2048
    s_add_u32 s38, s83, s91
    ds_read_b128 a[36:39], v6 offset:6144
    s_waitcnt lgkmcnt(3)
    buffer_load_dwordx4 v13, s[12:15], s38 offen lds
    ds_read_b128 a[52:55], v7 offset:6144
    buffer_load_dwordx4 v14, s[12:15], s38 offen offset:1024 lds
    s_waitcnt vmcnt(14)
    s_barrier
    ds_read_b128 v[168:171], v21 offset:36864
    ds_read_b128 a[40:43], v6 offset:8192
    ds_read_b128 v[172:175], v21 offset:37888
    ds_read_b128 v[176:179], v21 offset:38912
    s_add_u32 m0, s40, 4096
    s_add_u32 s38, s84, s88
    s_waitcnt lgkmcnt(6)
    buffer_load_dwordx4 v13, s[12:15], s38 offen lds
    ds_read_b128 v[180:183], v21 offset:39936
    ds_read_b128 v[184:187], v21 offset:40960
    ds_read_b128 a[56:59], v7 offset:8192
    ds_read_b128 v[188:191], v21 offset:41984
    ds_read_b128 v[200:203], v21 offset:43008
    buffer_load_dwordx4 v14, s[12:15], s38 offen offset:1024 lds
    s_add_u32 m0, s41, 12288
    s_add_u32 s57, s57, 98304
    s_cmp_eq_u32 s57, 983040
    s_cselect_b32 s57, 0, s57
    s_waitcnt lgkmcnt(5)
    v_mfma_f32_16x16x32_bf16 v[144:147], v[168:171], v[32:35], 0
    ds_read_b128 v[204:207], v21 offset:44032
    v_mfma_f32_16x16x32_bf16 v[148:151], v[172:175], v[32:35], 0
    buffer_load_dwordx4 v12, s[24:27], s57 offen sc1 lds
    ds_read_b128 v[208:211], v21 offset:45056
    v_mfma_f32_16x16x32_bf16 v[152:155], v[176:179], v[32:35], 0
    ds_read_b128 v[212:215], v21 offset:46080
    buffer_load_dwordx4 v12, s[24:27], s57 offen offset:1024 sc1 lds
    s_waitcnt lgkmcnt(4)
    v_mfma_f32_16x16x32_bf16 v[156:159], v[180:183], v[32:35], 0
    ds_read_b128 v[216:219], v21 offset:47104
    buffer_load_dwordx4 v12, s[24:27], s57 offen offset:2048 sc1 lds
    s_add_u32 m0, s40, 6144
    s_add_u32 s38, s84, s89
    v_mfma_f32_16x16x32_bf16 v[160:163], v[184:187], v[32:35], 0
    ds_read_b128 v[220:223], v21 offset:48128
    v_mfma_f32_16x16x32_bf16 v[164:167], v[188:191], v[32:35], 0
    s_waitcnt vmcnt(16)
    s_barrier
    ds_read_b128 v[168:171], v21 offset:49152
    ds_read_b128 a[44:47], v6 offset:10240
    s_waitcnt lgkmcnt(5)
    v_mfma_f32_16x16x32_bf16 v[144:147], v[200:203], v[36:39], v[144:147]
    ds_read_b128 v[172:175], v21 offset:50176
    v_mfma_f32_16x16x32_bf16 v[148:151], v[204:207], v[36:39], v[148:151]
    buffer_load_dwordx4 v13, s[12:15], s38 offen lds
    ds_read_b128 v[176:179], v21 offset:51200
    v_mfma_f32_16x16x32_bf16 v[152:155], v[208:211], v[36:39], v[152:155]
    ds_read_b128 v[180:183], v21 offset:52224
    ds_read_b128 a[60:63], v7 offset:10240
    s_waitcnt lgkmcnt(6)
    v_mfma_f32_16x16x32_bf16 v[156:159], v[212:215], v[36:39], v[156:159]
    ds_read_b128 v[184:187], v21 offset:53248
    v_mfma_f32_16x16x32_bf16 v[160:163], v[216:219], v[36:39], v[160:163]
    ds_read_b128 v[188:191], v21 offset:54272
    buffer_load_dwordx4 v14, s[12:15], s38 offen offset:1024 lds
    s_add_u32 m0, s41, 24576
    s_add_u32 s57, s57, 98304
    s_cmp_eq_u32 s57, 983040
    s_cselect_b32 s57, 0, s57
    v_mfma_f32_16x16x32_bf16 v[164:167], v[220:223], v[36:39], v[164:167]
    ds_read_b128 v[200:203], v21 offset:55296
    s_waitcnt lgkmcnt(5)
    v_mfma_f32_16x16x32_bf16 v[144:147], v[168:171], v[40:43], v[144:147]
    buffer_load_dwordx4 v12, s[24:27], s57 offen sc1 lds
    ds_read_b128 v[204:207], v21 offset:56320
    v_mfma_f32_16x16x32_bf16 v[148:151], v[172:175], v[40:43], v[148:151]
    ds_read_b128 v[208:211], v21 offset:57344
    v_mfma_f32_16x16x32_bf16 v[152:155], v[176:179], v[40:43], v[152:155]
    buffer_load_dwordx4 v12, s[24:27], s57 offen offset:1024 sc1 lds
    ds_read_b128 v[212:215], v21 offset:58368
    s_waitcnt lgkmcnt(4)
    v_mfma_f32_16x16x32_bf16 v[156:159], v[180:183], v[40:43], v[156:159]
    ds_read_b128 v[216:219], v21 offset:59392
    buffer_load_dwordx4 v12, s[24:27], s57 offen offset:2048 sc1 lds
    s_add_u32 m0, s40, 8192
    s_add_u32 s38, s84, s90
    v_mfma_f32_16x16x32_bf16 v[160:163], v[184:187], v[40:43], v[160:163]
    ds_read_b128 v[220:223], v21 offset:60416
    v_mfma_f32_16x16x32_bf16 v[164:167], v[188:191], v[40:43], v[164:167]
    s_waitcnt vmcnt(18)
    s_barrier
    ds_read_b128 v[168:171], v21 offset:0
    ds_read_b128 a[64:67], v6 offset:12288
    s_waitcnt lgkmcnt(5)
    v_mfma_f32_16x16x32_bf16 v[144:147], v[200:203], v[44:47], v[144:147]
    ds_read_b128 v[172:175], v21 offset:1024
    v_mfma_f32_16x16x32_bf16 v[148:151], v[204:207], v[44:47], v[148:151]
    buffer_load_dwordx4 v13, s[12:15], s38 offen lds
    ds_read_b128 v[176:179], v21 offset:2048
    v_mfma_f32_16x16x32_bf16 v[152:155], v[208:211], v[44:47], v[152:155]
    ds_read_b128 v[180:183], v21 offset:3072
    ds_read_b128 a[80:83], v7 offset:12288
    s_waitcnt lgkmcnt(6)
    v_mfma_f32_16x16x32_bf16 v[156:159], v[212:215], v[44:47], v[156:159]
    ds_read_b128 v[184:187], v21 offset:4096
    v_mfma_f32_16x16x32_bf16 v[160:163], v[216:219], v[44:47], v[160:163]
    ds_read_b128 v[188:191], v21 offset:5120
    buffer_load_dwordx4 v14, s[12:15], s38 offen offset:1024 lds
    s_add_u32 m0, s41, 36864
    s_add_u32 s57, s57, 98304
    s_cmp_eq_u32 s57, 983040
    s_cselect_b32 s57, 0, s57
    v_mfma_f32_16x16x32_bf16 v[164:167], v[220:223], v[44:47], v[164:167]
    ds_read_b128 v[200:203], v21 offset:6144
    s_waitcnt lgkmcnt(5)
    v_mfma_f32_16x16x32_bf16 v[144:147], v[168:171], v[48:51], v[144:147]
    buffer_load_dwordx4 v12, s[24:27], s57 offen sc1 lds
    ds_read_b128 v[204:207], v21 offset:7168
    v_mfma_f32_16x16x32_bf16 v[148:151], v[172:175], v[48:51], v[148:151]
    ds_read_b128 v[208:211], v21 offset:8192
    v_mfma_f32_16x16x32_bf16 v[152:155], v[176:179], v[48:51], v[152:155]
    buffer_load_dwordx4 v12, s[24:27], s57 offen offset:1024 sc1 lds
    ds_read_b128 v[212:215], v21 offset:9216
    s_waitcnt lgkmcnt(4)
    v_mfma_f32_16x16x32_bf16 v[156:159], v[180:183], v[48:51], v[156:159]
    ds_read_b128 v[216:219], v21 offset:10240
    buffer_load_dwordx4 v12, s[24:27], s57 offen offset:2048 sc1 lds
    s_add_u32 m0, s40, 10240
    s_add_u32 s38, s84, s91
    v_mfma_f32_16x16x32_bf16 v[160:163], v[184:187], v[48:51], v[160:163]
    ds_read_b128 v[220:223], v21 offset:11264
    v_mfma_f32_16x16x32_bf16 v[164:167], v[188:191], v[48:51], v[164:167]
    s_waitcnt vmcnt(10)
    s_barrier
    ds_read_b128 v[168:171], v21 offset:12288
    ds_read_b128 a[68:71], v6 offset:14336
    s_waitcnt lgkmcnt(5)
    v_mfma_f32_16x16x32_bf16 v[144:147], v[200:203], v[52:55], v[144:147]
    ds_read_b128 v[172:175], v21 offset:13312
    v_mfma_f32_16x16x32_bf16 v[148:151], v[204:207], v[52:55], v[148:151]
    buffer_load_dwordx4 v13, s[12:15], s38 offen lds
    ds_read_b128 v[176:179], v21 offset:14336
    v_mfma_f32_16x16x32_bf16 v[152:155], v[208:211], v[52:55], v[152:155]
    ds_read_b128 v[180:183], v21 offset:15360
    ds_read_b128 a[84:87], v7 offset:14336
    s_waitcnt lgkmcnt(6)
    v_mfma_f32_16x16x32_bf16 v[156:159], v[212:215], v[52:55], v[156:159]
    ds_read_b128 v[184:187], v21 offset:16384
    v_mfma_f32_16x16x32_bf16 v[160:163], v[216:219], v[52:55], v[160:163]
    ds_read_b128 v[188:191], v21 offset:17408
    buffer_load_dwordx4 v14, s[12:15], s38 offen offset:1024 lds
    s_add_u32 m0, s41, 49152
    s_add_u32 s57, s57, 98304
    s_cmp_eq_u32 s57, 983040
    s_cselect_b32 s57, 0, s57
    v_mfma_f32_16x16x32_bf16 v[164:167], v[220:223], v[52:55], v[164:167]
    ds_read_b128 v[200:203], v21 offset:18432
    s_waitcnt lgkmcnt(5)
    v_mfma_f32_16x16x32_bf16 v[144:147], v[168:171], v[56:59], v[144:147]
    buffer_load_dwordx4 v12, s[24:27], s57 offen sc1 lds
    ds_read_b128 v[204:207], v21 offset:19456
    v_mfma_f32_16x16x32_bf16 v[148:151], v[172:175], v[56:59], v[148:151]
    ds_read_b128 v[208:211], v21 offset:20480
    v_mfma_f32_16x16x32_bf16 v[152:155], v[176:179], v[56:59], v[152:155]
    buffer_load_dwordx4 v12, s[24:27], s57 offen offset:1024 sc1 lds
    ds_read_b128 v[212:215], v21 offset:21504
    s_waitcnt lgkmcnt(4)
    v_mfma_f32_16x16x32_bf16 v[156:159], v[180:183], v[56:59], v[156:159]
    ds_read_b128 v[216:219], v21 offset:22528
    buffer_load_dwordx4 v12, s[24:27], s57 offen offset:2048 sc1 lds
    s_add_u32 m0, s40, 12288
    s_add_u32 s38, s85, s88
    v_mfma_f32_16x16x32_bf16 v[160:163], v[184:187], v[56:59], v[160:163]
    ds_read_b128 v[220:223], v21 offset:23552
    v_mfma_f32_16x16x32_bf16 v[164:167], v[188:191], v[56:59], v[164:167]
    s_waitcnt vmcnt(10)
    s_barrier
    ds_read_b128 v[168:171], v21 offset:24576
    ds_read_b128 a[72:75], v6 offset:16384
    s_waitcnt lgkmcnt(5)
    v_mfma_f32_16x16x32_bf16 v[144:147], v[200:203], v[60:63], v[144:147]
    ds_read_b128 v[172:175], v21 offset:25600
    v_mfma_f32_16x16x32_bf16 v[148:151], v[204:207], v[60:63], v[148:151]
    buffer_load_dwordx4 v13, s[12:15], s38 offen lds
    ds_read_b128 v[176:179], v21 offset:26624
    v_mfma_f32_16x16x32_bf16 v[152:155], v[208:211], v[60:63], v[152:155]
    ds_read_b128 v[180:183], v21 offset:27648
    ds_read_b128 a[88:91], v7 offset:16384
    s_waitcnt lgkmcnt(6)
    v_mfma_f32_16x16x32_bf16 v[156:159], v[212:215], v[60:63], v[156:159]
    ds_read_b128 v[184:187], v21 offset:28672
    v_mfma_f32_16x16x32_bf16 v[160:163], v[216:219], v[60:63], v[160:163]
    ds_read_b128 v[188:191], v21 offset:29696
    buffer_load_dwordx4 v14, s[12:15], s38 offen offset:1024 lds
    s_add_u32 m0, s41, 0
    s_add_u32 s57, s57, 98304
    s_cmp_eq_u32 s57, 983040
    s_cselect_b32 s57, 0, s57
    v_mfma_f32_16x16x32_bf16 v[164:167], v[220:223], v[60:63], v[164:167]
    ds_read_b128 v[200:203], v21 offset:30720
    s_waitcnt lgkmcnt(5)
    v_mfma_f32_16x16x32_bf16 v[144:147], v[168:171], v[64:67], v[144:147]
    buffer_load_dwordx4 v12, s[24:27], s57 offen sc1 lds
    ds_read_b128 v[204:207], v21 offset:31744
    v_mfma_f32_16x16x32_bf16 v[148:151], v[172:175], v[64:67], v[148:151]
    ds_read_b128 v[208:211], v21 offset:32768
    v_mfma_f32_16x16x32_bf16 v[152:155], v[176:179], v[64:67], v[152:155]
    buffer_load_dwordx4 v12, s[24:27], s57 offen offset:1024 sc1 lds
    ds_read_b128 v[212:215], v21 offset:33792
    s_waitcnt lgkmcnt(4)
    v_mfma_f32_16x16x32_bf16 v[156:159], v[180:183], v[64:67], v[156:159]
    ds_read_b128 v[216:219], v21 offset:34816
    buffer_load_dwordx4 v12, s[24:27], s57 offen offset:2048 sc1 lds
    s_add_u32 m0, s40, 14336
    s_add_u32 s38, s85, s89
    v_mfma_f32_16x16x32_bf16 v[160:163], v[184:187], v[64:67], v[160:163]
    ds_read_b128 v[220:223], v21 offset:35840
    v_mfma_f32_16x16x32_bf16 v[164:167], v[188:191], v[64:67], v[164:167]
    s_waitcnt vmcnt(10)
    s_barrier
    buffer_load_dwordx4 v[232:235], v18, s[24:27], 0 offen sc1
    buffer_load_dwordx4 v[236:239], v18, s[24:27], 0 offen offset:1024 sc1
    ds_read_b128 v[168:171], v21 offset:36864
    ds_read_b128 a[76:79], v6 offset:18432
    s_waitcnt lgkmcnt(5)
    v_mfma_f32_16x16x32_bf16 v[144:147], v[200:203], v[68:71], v[144:147]
    ds_read_b128 v[172:175], v21 offset:37888
    v_mfma_f32_16x16x32_bf16 v[148:151], v[204:207], v[68:71], v[148:151]
    buffer_load_dwordx4 v13, s[12:15], s38 offen lds
    ds_read_b128 v[176:179], v21 offset:38912
    v_mfma_f32_16x16x32_bf16 v[152:155], v[208:211], v[68:71], v[152:155]
    ds_read_b128 v[180:183], v21 offset:39936
    ds_read_b128 a[92:95], v7 offset:18432
    s_waitcnt lgkmcnt(6)
    v_mfma_f32_16x16x32_bf16 v[156:159], v[212:215], v[68:71], v[156:159]
    ds_read_b128 v[184:187], v21 offset:40960
    v_mfma_f32_16x16x32_bf16 v[160:163], v[216:219], v[68:71], v[160:163]
    ds_read_b128 v[188:191], v21 offset:41984
    buffer_load_dwordx4 v14, s[12:15], s38 offen offset:1024 lds
    s_add_u32 m0, s41, 12288
    s_add_u32 s57, s57, 98304
    s_cmp_eq_u32 s57, 983040
    s_cselect_b32 s57, 0, s57
    v_mfma_f32_16x16x32_bf16 v[164:167], v[220:223], v[68:71], v[164:167]
    ds_read_b128 v[200:203], v21 offset:43008
    s_waitcnt lgkmcnt(5)
    v_mfma_f32_16x16x32_bf16 v[144:147], v[168:171], v[72:75], v[144:147]
    buffer_load_dwordx4 v12, s[24:27], s57 offen sc1 lds
    ds_read_b128 v[204:207], v21 offset:44032
    v_mfma_f32_16x16x32_bf16 v[148:151], v[172:175], v[72:75], v[148:151]
    ds_read_b128 v[208:211], v21 offset:45056
    v_mfma_f32_16x16x32_bf16 v[152:155], v[176:179], v[72:75], v[152:155]
    buffer_load_dwordx4 v12, s[24:27], s57 offen offset:1024 sc1 lds
    ds_read_b128 v[212:215], v21 offset:46080
    s_waitcnt lgkmcnt(4)
    v_mfma_f32_16x16x32_bf16 v[156:159], v[180:183], v[72:75], v[156:159]
    ds_read_b128 v[216:219], v21 offset:47104
    buffer_load_dwordx4 v12, s[24:27], s57 offen offset:2048 sc1 lds
    s_add_u32 m0, s40, 16384
    s_add_u32 s38, s85, s90
    v_mfma_f32_16x16x32_bf16 v[160:163], v[184:187], v[72:75], v[160:163]
    ds_read_b128 v[220:223], v21 offset:48128
    v_mfma_f32_16x16x32_bf16 v[164:167], v[188:191], v[72:75], v[164:167]
    s_waitcnt vmcnt(12)
    s_barrier
    ds_read_b128 v[168:171], v21 offset:49152
    ds_read_b128 a[96:99], v6 offset:20480
    s_waitcnt lgkmcnt(5)
    v_mfma_f32_16x16x32_bf16 v[144:147], v[200:203], v[76:79], v[144:147]
    ds_read_b128 v[172:175], v21 offset:50176
    v_mfma_f32_16x16x32_bf16 v[148:151], v[204:207], v[76:79], v[148:151]
    buffer_load_dwordx4 v13, s[12:15], s38 offen lds
    ds_read_b128 v[176:179], v21 offset:51200
    v_mfma_f32_16x16x32_bf16 v[152:155], v[208:211], v[76:79], v[152:155]
    ds_read_b128 v[180:183], v21 offset:52224
    ds_read_b128 a[112:115], v7 offset:20480
    s_waitcnt lgkmcnt(6)
    v_mfma_f32_16x16x32_bf16 v[156:159], v[212:215], v[76:79], v[156:159]
    ds_read_b128 v[184:187], v21 offset:53248
    v_mfma_f32_16x16x32_bf16 v[160:163], v[216:219], v[76:79], v[160:163]
    ds_read_b128 v[188:191], v21 offset:54272
    buffer_load_dwordx4 v14, s[12:15], s38 offen offset:1024 lds
    s_add_u32 m0, s41, 24576
    s_add_u32 s57, s57, 98304
    s_cmp_eq_u32 s57, 983040
    s_cselect_b32 s57, 0, s57
    v_mfma_f32_16x16x32_bf16 v[164:167], v[220:223], v[76:79], v[164:167]
    ds_read_b128 v[200:203], v21 offset:55296
    s_waitcnt lgkmcnt(5)
    v_mfma_f32_16x16x32_bf16 v[144:147], v[168:171], v[80:83], v[144:147]
    buffer_load_dwordx4 v12, s[24:27], s57 offen sc1 lds
    ds_read_b128 v[204:207], v21 offset:56320
    v_mfma_f32_16x16x32_bf16 v[148:151], v[172:175], v[80:83], v[148:151]
    ds_read_b128 v[208:211], v21 offset:57344
    v_mfma_f32_16x16x32_bf16 v[152:155], v[176:179], v[80:83], v[152:155]
    buffer_load_dwordx4 v12, s[24:27], s57 offen offset:1024 sc1 lds
    ds_read_b128 v[212:215], v21 offset:58368
    s_waitcnt lgkmcnt(4)
    v_mfma_f32_16x16x32_bf16 v[156:159], v[180:183], v[80:83], v[156:159]
    ds_read_b128 v[216:219], v21 offset:59392
    buffer_load_dwordx4 v12, s[24:27], s57 offen offset:2048 sc1 lds
    s_add_u32 m0, s40, 18432
    s_add_u32 s38, s85, s91
    v_mfma_f32_16x16x32_bf16 v[160:163], v[184:187], v[80:83], v[160:163]
    ds_read_b128 v[220:223], v21 offset:60416
    v_mfma_f32_16x16x32_bf16 v[164:167], v[188:191], v[80:83], v[164:167]
    s_waitcnt vmcnt(12)
    s_barrier
    ds_read_b128 a[100:103], v6 offset:22528
    ds_read_b128 v[168:171], v21 offset:0
    s_waitcnt lgkmcnt(5)
    v_mfma_f32_16x16x32_bf16 v[144:147], v[200:203], v[84:87], v[144:147]
    buffer_load_dwordx4 v13, s[12:15], s38 offen lds
    ds_read_b128 v[172:175], v21 offset:1024
    v_mfma_f32_16x16x32_bf16 v[148:151], v[204:207], v[84:87], v[148:151]
    ds_read_b128 a[116:119], v7 offset:22528
    ds_read_b128 v[176:179], v21 offset:2048
    v_mfma_f32_16x16x32_bf16 v[152:155], v[208:211], v[84:87], v[152:155]
    buffer_load_dwordx4 v14, s[12:15], s38 offen offset:1024 lds
    s_add_u32 m0, s40, 20480
    s_add_u32 s38, s86, s88
    ds_read_b128 v[180:183], v21 offset:3072
    s_waitcnt lgkmcnt(6)
    v_mfma_f32_16x16x32_bf16 v[156:159], v[212:215], v[84:87], v[156:159]
    ds_read_b128 a[104:107], v6 offset:0
    ds_read_b128 v[184:187], v21 offset:4096
    v_mfma_f32_16x16x32_bf16 v[160:163], v[216:219], v[84:87], v[160:163]
    buffer_load_dwordx4 v13, s[12:15], s38 offen lds
    ds_read_b128 v[188:191], v21 offset:5120
    v_mfma_f32_16x16x32_bf16 v[164:167], v[220:223], v[84:87], v[164:167]
    ds_read_b128 a[120:123], v7 offset:0
    ds_read_b128 v[200:203], v21 offset:6144
    s_waitcnt lgkmcnt(6)
    v_mfma_f32_16x16x32_bf16 v[144:147], v[168:171], v[88:91], v[144:147]
    buffer_load_dwordx4 v14, s[12:15], s38 offen offset:1024 lds
L_page7:
    s_cbranch_execz L_ret1
    s_add_u32 m0, s40, 22528
    s_add_u32 s38, s86, s89
    ds_read_b128 v[204:207], v21 offset:7168
    v_mfma_f32_16x16x32_bf16 v[148:151], v[172:175], v[88:91], v[148:151]
    ds_read_b128 a[108:111], v6 offset:2048
    ds_read_b128 v[208:211], v21 offset:8192
    v_mfma_f32_16x16x32_bf16 v[152:155], v[176:179], v[88:91], v[152:155]
    buffer_load_dwordx4 v13, s[12:15], s38 offen lds
    ds_read_b128 v[212:215], v21 offset:9216
    s_waitcnt lgkmcnt(6)
    v_mfma_f32_16x16x32_bf16 v[156:159], v[180:183], v[88:91], v[156:159]
    ds_read_b128 a[124:127], v7 offset:2048
    ds_read_b128 v[216:219], v21 offset:10240
    v_mfma_f32_16x16x32_bf16 v[160:163], v[184:187], v[88:91], v[160:163]
    buffer_load_dwordx4 v14, s[12:15], s38 offen offset:1024 lds
    s_add_u32 m0, s40, 0
    s_add_u32 s38, s86, s90
    ds_read_b128 v[220:223], v21 offset:11264
    v_mfma_f32_16x16x32_bf16 v[164:167], v[188:191], v[88:91], v[164:167]
    s_waitcnt vmcnt(16)
    s_mov_b32 s39, 0
L_h1h_chk:
    v_cmp_ne_u32 vcc, s35, v233
    v_cmp_ne_u32 s[48:49], s35, v235
    s_or_b64 vcc, vcc, s[48:49]
    v_cmp_ne_u32 s[48:49], s35, v237
    s_or_b64 vcc, vcc, s[48:49]
    v_cmp_ne_u32 s[48:49], s35, v239
    s_or_b64 vcc, vcc, s[48:49]
    s_cbranch_scc0 L_h1h_ok
    s_add_u32 s39, s39, 1
    s_cmp_lt_u32 s39, 400000
    s_cbranch_scc0 L_h1h_ok
    buffer_load_dwordx4 v[232:235], v18, s[24:27], 0 offen sc1
    buffer_load_dwordx4 v[236:239], v18, s[24:27], 0 offen offset:1024 sc1
    s_waitcnt vmcnt(0)
    s_branch L_h1h_chk
L_h1h_ok:
    s_waitcnt vmcnt(11)
    s_barrier
    ds_read_b128 a[128:131], v6 offset:4096
    ds_read_b128 v[168:171], v21 offset:12288
    s_waitcnt lgkmcnt(6)
    v_mfma_f32_16x16x32_bf16 v[144:147], v[200:203], v[92:95], v[144:147]
    buffer_load_dwordx4 v13, s[12:15], s38 offen lds
    ds_read_b128 v[172:175], v21 offset:13312
    v_mfma_f32_16x16x32_bf16 v[148:151], v[204:207], v[92:95], v[148:151]
    ds_read_b128 a[144:147], v7 offset:4096
    ds_read_b128 v[176:179], v21 offset:14336
    v_mfma_f32_16x16x32_bf16 v[152:155], v[208:211], v[92:95], v[152:155]
    buffer_load_dwordx4 v14, s[12:15], s38 offen offset:1024 lds
    s_add_u32 m0, s40, 2048
    s_add_u32 s38, s86, s91
    ds_read_b128 v[180:183], v21 offset:15360
    s_waitcnt lgkmcnt(6)
    v_mfma_f32_16x16x32_bf16 v[156:159], v[212:215], v[92:95], v[156:159]
    ds_read_b128 a[132:135], v6 offset:6144
    ds_read_b128 v[184:187], v21 offset:16384
    v_mfma_f32_16x16x32_bf16 v[160:163], v[216:219], v[92:95], v[160:163]
    buffer_load_dwordx4 v13, s[12:15], s38 offen lds
    ds_read_b128 v[188:191], v21 offset:17408
    v_mfma_f32_16x16x32_bf16 v[164:167], v[220:223], v[92:95], v[164:167]
    ds_read_b128 a[148:151], v7 offset:6144
    ds_read_b128 v[200:203], v21 offset:18432
    s_waitcnt lgkmcnt(6)
    v_mfma_f32_16x16x32_bf16 v[144:147], v[168:171], v[96:99], v[144:147]
    buffer_load_dwordx4 v14, s[12:15], s38 offen offset:1024 lds
    s_add_u32 m0, s40, 4096
    s_add_u32 s38, s87, s88
    ds_read_b128 v[204:207], v21 offset:19456
    v_mfma_f32_16x16x32_bf16 v[148:151], v[172:175], v[96:99], v[148:151]
    ds_read_b128 a[136:139], v6 offset:8192
    buffer_load_dword v17, v22, s[24:27], s97 offen sc1
    ds_read_b128 v[208:211], v21 offset:20480
    v_mfma_f32_16x16x32_bf16 v[152:155], v[176:179], v[96:99], v[152:155]
    buffer_load_dwordx4 v13, s[12:15], s38 offen lds
    ds_read_b128 v[212:215], v21 offset:21504
    s_waitcnt lgkmcnt(6)
    v_mfma_f32_16x16x32_bf16 v[156:159], v[180:183], v[96:99], v[156:159]
    ds_read_b128 a[152:155], v7 offset:8192
    ds_read_b128 v[216:219], v21 offset:22528
    v_mfma_f32_16x16x32_bf16 v[160:163], v[184:187], v[96:99], v[160:163]
    buffer_load_dwordx4 v14, s[12:15], s38 offen offset:1024 lds
    s_add_u32 m0, s40, 6144
    s_add_u32 s38, s87, s89
    ds_read_b128 v[220:223], v21 offset:23552
    v_mfma_f32_16x16x32_bf16 v[164:167], v[188:191], v[96:99], v[164:167]
    s_waitcnt vmcnt(13)
    s_barrier
    ds_read_b128 a[140:143], v6 offset:10240
    ds_read_b128 v[168:171], v21 offset:24576
    s_waitcnt lgkmcnt(6)
    v_mfma_f32_16x16x32_bf16 v[144:147], v[200:203], v[100:103], v[144:147]
    buffer_load_dwordx4 v13, s[12:15], s38 offen lds
    ds_read_b128 v[172:175], v21 offset:25600
    v_mfma_f32_16x16x32_bf16 v[148:151], v[204:207], v[100:103], v[148:151]
    ds_read_b128 v[176:179], v21 offset:26624
    ds_read_b128 a[156:159], v7 offset:10240
    v_mfma_f32_16x16x32_bf16 v[152:155], v[208:211], v[100:103], v[152:155]
    ds_read_b128 v[180:183], v21 offset:27648
    buffer_load_dwordx4 v14, s[12:15], s38 offen offset:1024 lds
    s_add_u32 m0, s40, 8192
    s_add_u32 s38, s87, s90
    s_waitcnt lgkmcnt(6)
    v_mfma_f32_16x16x32_bf16 v[156:159], v[212:215], v[100:103], v[156:159]
    ds_read_b128 v[184:187], v21 offset:28672
    ds_read_b128 a[160:163], v6 offset:12288
    v_mfma_f32_16x16x32_bf16 v[160:163], v[216:219], v[100:103], v[160:163]
    ds_read_b128 v[188:191], v21 offset:29696
    v_mfma_f32_16x16x32_bf16 v[164:167], v[220:223], v[100:103], v[164:167]
    buffer_load_dwordx4 v13, s[12:15], s38 offen lds
    ds_read_b128 v[200:203], v21 offset:30720
    s_waitcnt lgkmcnt(6)
    v_mfma_f32_16x16x32_bf16 v[144:147], v[168:171], v[104:107], v[144:147]
    ds_read_b128 a[176:179], v7 offset:12288
    ds_read_b128 v[204:207], v21 offset:31744
    v_mfma_f32_16x16x32_bf16 v[148:151], v[172:175], v[104:107], v[148:151]
    ds_read_b128 v[208:211], v21 offset:32768
    buffer_load_dwordx4 v14, s[12:15], s38 offen offset:1024 lds
    s_add_u32 m0, s40, 10240
    s_add_u32 s38, s87, s91
    v_mfma_f32_16x16x32_bf16 v[152:155], v[176:179], v[104:107], v[152:155]
    ds_read_b128 v[212:215], v21 offset:33792
    ds_read_b128 a[164:167], v6 offset:14336
    s_waitcnt lgkmcnt(6)
    v_mfma_f32_16x16x32_bf16 v[156:159], v[180:183], v[104:107], v[156:159]
    ds_read_b128 v[216:219], v21 offset:34816
    v_mfma_f32_16x16x32_bf16 v[160:163], v[184:187], v[104:107], v[160:163]
    buffer_load_dwordx4 v13, s[12:15], s38 offen lds
    ds_read_b128 v[220:223], v21 offset:35840
    v_mfma_f32_16x16x32_bf16 v[164:167], v[188:191], v[104:107], v[164:167]
    ds_read_b128 a[180:183], v7 offset:14336
    s_waitcnt lgkmcnt(6)
    v_mfma_f32_16x16x32_bf16 v[144:147], v[200:203], v[108:111], v[144:147]
    v_mfma_f32_16x16x32_bf16 v[148:151], v[204:207], v[108:111], v[148:151]
    s_waitcnt lgkmcnt(4)
    v_mfma_f32_16x16x32_bf16 v[152:155], v[208:211], v[108:111], v[152:155]
    buffer_load_dwordx4 v14, s[12:15], s38 offen offset:1024 lds
    v_mfma_f32_16x16x32_bf16 v[156:159], v[212:215], v[108:111], v[156:159]
    s_waitcnt lgkmcnt(1)
    v_mfma_f32_16x16x32_bf16 v[160:163], v[216:219], v[108:111], v[160:163]
    v_mfma_f32_16x16x32_bf16 v[164:167], v[220:223], v[108:111], v[164:167]
    s_waitcnt vmcnt(8)
    s_mov_b32 s39, 0
L_h2h_chk:
    v_cmp_ne_u32 vcc, s35, v17
    s_cmp_lg_u64 vcc, 0
    s_cbranch_scc0 L_h2h_ok
    s_add_u32 s39, s39, 1
    s_cmp_lt_u32 s39, 400000
    s_cbranch_scc0 L_h2h_ok
    buffer_load_dword v17, v22, s[24:27], s97 offen sc1
    s_waitcnt vmcnt(0)
    s_branch L_h2h_chk
L_h2h_ok:
    v_lshlrev_b32 v128, 16, v16
    v_lshlrev_b32 v129, 16, v16
    v_lshlrev_b32 v130, 16, v16
    v_lshlrev_b32 v131, 16, v16
    ds_read_b128 a[168:171], v6 offset:16384
    buffer_load_dwordx4 v[32:35], v20, s[24:27], s72 offen sc1
    ds_read_b128 a[184:187], v7 offset:16384
    buffer_load_dwordx4 v[36:39], v20, s[24:27], s72 offen offset:1024 sc1
    ds_read_b128 a[172:175], v6 offset:18432
    ds_read_b128 a[188:191], v7 offset:18432
    buffer_load_dwordx4 v[40:43], v20, s[24:27], s73 offen sc1
    ds_read_b128 a[192:195], v6 offset:20480
    ds_read_b128 a[208:211], v7 offset:20480
    buffer_load_dwordx4 v[44:47], v20, s[24:27], s73 offen offset:1024 sc1
    ds_read_b128 a[196:199], v6 offset:22528
    ds_read_b128 a[212:215], v7 offset:22528
    buffer_load_dwordx4 v[48:51], v20, s[24:27], s74 offen sc1
    ds_read_b128 a[200:203], v6 offset:0
    buffer_load_dwordx4 v[52:55], v20, s[24:27], s74 offen offset:1024 sc1
    ds_read_b128 a[216:219], v7 offset:0
    ds_read_b128 a[204:207], v6 offset:2048
    buffer_load_dwordx4 v[56:59], v20, s[24:27], s75 offen sc1
    ds_read_b128 a[220:223], v7 offset:2048
    buffer_load_dwordx4 v[60:63], v20, s[24:27], s75 offen offset:1024 sc1
    s_waitcnt vmcnt(14)
    ds_read_b128 a[224:227], v6 offset:4096
    ds_read_b128 a[240:243], v7 offset:4096
    buffer_load_dwordx4 v[64:67], v20, s[24:27], s76 offen sc1
    s_waitcnt vmcnt(13)
    ds_read_b128 a[228:231], v6 offset:6144
    ds_read_b128 a[244:247], v7 offset:6144
    buffer_load_dwordx4 v[68:71], v20, s[24:27], s76 offen offset:1024 sc1
    s_waitcnt vmcnt(12)
    ds_read_b128 a[232:235], v6 offset:8192
    ds_read_b128 a[248:251], v7 offset:8192
    buffer_load_dwordx4 v[72:75], v20, s[24:27], s77 offen sc1
    s_waitcnt vmcnt(11)
    ds_read_b128 a[236:239], v6 offset:10240
    buffer_load_dwordx4 v[76:79], v20, s[24:27], s77 offen offset:1024 sc1
    ds_read_b128 a[252:255], v7 offset:10240
    s_waitcnt lgkmcnt(0)
    s_branch L_join
L_hs1:
    s_add_u32 s39, s39, 1
    s_cmp_lt_u32 s39, 400000
    s_cbranch_scc0 L_hk1
    buffer_load_dwordx4 v[100:103], v21, s[24:27], s59 offen offset:0 sc1
    buffer_load_dwordx4 v[104:107], v21, s[24:27], s60 offen offset:0 sc1
    buffer_load_dwordx4 v[108:111], v21, s[24:27], s61 offen offset:0 sc1
    buffer_load_dwordx4 v[112:115], v21, s[24:27], s62 offen offset:0 sc1
    buffer_load_dwordx4 v[116:119], v21, s[24:27], s63 offen offset:0 sc1
    buffer_load_dwordx4 v[120:123], v21, s[24:27], s64 offen offset:0 sc1
    buffer_load_dwordx4 v[124:127], v21, s[24:27], s65 offen offset:0 sc1
    s_waitcnt vmcnt(0)
    v_max3_u32 v200, v100, v102, v104
    v_max3_u32 v200, v200, v106, v108
    v_max_u32 v200, v200, v110
    v_cmp_eq_u32 vcc, -1, v200
    s_cmp_lg_u64 vcc, 0
    s_cbranch_scc1 L_hs1
    s_branch L_hk1
L_hs4:
    s_add_u32 s39, s39, 1
    s_cmp_lt_u32 s39, 400000
    s_cbranch_scc0 L_hk4
    buffer_load_dwordx4 v[112:115], v21, s[24:27], s62 offen offset:0 sc1
    buffer_load_dwordx4 v[116:119], v21, s[24:27], s63 offen offset:0 sc1
    buffer_load_dwordx4 v[120:123], v21, s[24:27], s64 offen offset:0 sc1
    buffer_load_dwordx4 v[124:127], v21, s[24:27], s65 offen offset:0 sc1
    s_waitcnt vmcnt(0)
    v_max3_u32 v200, v112, v114, v116
    v_max3_u32 v200, v200, v118, v120
    v_max3_u32 v200, v200, v122, v124
    v_max_u32 v200, v200, v126
    v_cmp_eq_u32 vcc, -1, v200
    s_cmp_lg_u64 vcc, 0
    s_cbranch_scc1 L_hs4
    s_branch L_hk4
L_hs9:
    s_add_u32 s39, s39, 1
    s_cmp_lt_u32 s39, 400000
    s_cbranch_scc0 L_hk9
    buffer_load_dwordx4 v[32:35], v21, s[24:27], s59 offen offset:1024 sc1
    buffer_load_dwordx4 v[36:39], v21, s[24:27], s60 offen offset:1024 sc1
    buffer_load_dwordx4 v[40:43], v21, s[24:27], s61 offen offset:1024 sc1
    buffer_load_dwordx4 v[44:47], v21, s[24:27], s62 offen offset:1024 sc1
    buffer_load_dwordx4 v[48:51], v21, s[24:27], s63 offen offset:1024 sc1
    buffer_load_dwordx4 v[52:55], v21, s[24:27], s64 offen offset:1024 sc1
    buffer_load_dwordx4 v[56:59], v21, s[24:27], s65 offen offset:1024 sc1
    s_waitcnt vmcnt(0)
    v_max3_u32 v200, v32, v34, v36
    v_max3_u32 v200, v200, v38, v40
    v_max_u32 v200, v200, v42
    v_cmp_eq_u32 vcc, -1, v200
    s_cmp_lg_u64 vcc, 0
    s_cbranch_scc1 L_hs9
    s_branch L_hk9
L_hs12:
    s_add_u32 s39, s39, 1
    s_cmp_lt_u32 s39, 400000
    s_cbranch_scc0 L_hk12
    buffer_load_dwordx4 v[44:47], v21, s[24:27], s62 offen offset:1024 sc1
    buffer_load_dwordx4 v[48:51], v21, s[24:27], s63 offen offset:1024 sc1
    buffer_load_dwordx4 v[52:55], v21, s[24:27], s64 offen offset:1024 sc1
    buffer_load_dwordx4 v[56:59], v21, s[24:27], s65 offen offset:1024 sc1
    s_waitcnt vmcnt(0)
    v_max3_u32 v200, v44, v46, v48
    v_max3_u32 v200, v200, v50, v52
    v_max3_u32 v200, v200, v54, v56
    v_max_u32 v200, v200, v58
    v_cmp_eq_u32 vcc, -1, v200
    s_cmp_lg_u64 vcc, 0
    s_cbranch_scc1 L_hs12
    s_branch L_hk12
L_hs17:
    s_add_u32 s39, s39, 1
    s_cmp_lt_u32 s39, 400000
    s_cbranch_scc0 L_hk17
    buffer_load_dwordx4 v[60:63], v21, s[24:27], s59 offen offset:2048 sc1
    buffer_load_dwordx4 v[64:67], v21, s[24:27], s60 offen offset:2048 sc1
    buffer_load_dwordx4 v[68:71], v21, s[24:27], s61 offen offset:2048 sc1
    buffer_load_dwordx4 v[72:75], v21, s[24:27], s62 offen offset:2048 sc1
    buffer_load_dwordx4 v[76:79], v21, s[24:27], s63 offen offset:2048 sc1
    buffer_load_dwordx4 v[80:83], v21, s[24:27], s64 offen offset:2048 sc1
    buffer_load_dwordx4 v[84:87], v21, s[24:27], s65 offen offset:2048 sc1
    s_waitcnt vmcnt(0)
    v_max3_u32 v200, v60, v62, v64
    v_max_u32 v200, v200, v66
    v_cmp_eq_u32 vcc, -1, v200
    s_cmp_lg_u64 vcc, 0
    s_cbranch_scc1 L_hs17
    s_branch L_hk17
L_hs19:
    s_add_u32 s39, s39, 1
    s_cmp_lt_u32 s39, 400000
    s_cbranch_scc0 L_hk19
    buffer_load_dwordx4 v[68:71], v21, s[24:27], s61 offen offset:2048 sc1
    buffer_load_dwordx4 v[72:75], v21, s[24:27], s62 offen offset:2048 sc1
    buffer_load_dwordx4 v[76:79], v21, s[24:27], s63 offen offset:2048 sc1
    buffer_load_dwordx4 v[80:83], v21, s[24:27], s64 offen offset:2048 sc1
    buffer_load_dwordx4 v[84:87], v21, s[24:27], s65 offen offset:2048 sc1
    s_waitcnt vmcnt(0)
    v_max3_u32 v200, v68, v70, v72
    v_max_u32 v200, v200, v74
    v_cmp_eq_u32 vcc, -1, v200
    s_cmp_lg_u64 vcc, 0
    s_cbranch_scc1 L_hs19
    s_branch L_hk19
L_hs21:
    s_add_u32 s39, s39, 1
    s_cmp_lt_u32 s39, 400000
    s_cbranch_scc0 L_hk21
    buffer_load_dwordx4 v[76:79], v21, s[24:27], s63 offen offset:2048 sc1
    buffer_load_dwordx4 v[80:83], v21, s[24:27], s64 offen offset:2048 sc1
    buffer_load_dwordx4 v[84:87], v21, s[24:27], s65 offen offset:2048 sc1
    s_waitcnt vmcnt(0)
    v_max3_u32 v200, v76, v78, v80
    v_max3_u32 v200, v200, v82, v84
    v_max_u32 v200, v200, v86
    v_cmp_eq_u32 vcc, -1, v200
    s_cmp_lg_u64 vcc, 0
    s_cbranch_scc1 L_hs21
    s_branch L_hk21
L_last:
    s_endpgm
.section .rodata,"a"
.p2align 6
.amdhsa_kernel standalone__mixer_gmlp__prompt_kernel
  .amdhsa_next_free_vgpr 512
  .amdhsa_next_free_sgpr 102
  .amdhsa_accum_offset 256
  .amdhsa_group_segment_fixed_size 0
  .amdhsa_kernarg_size 64
  .amdhsa_user_sgpr_count 2
  .amdhsa_user_sgpr_kernarg_segment_ptr 1
  .amdhsa_system_sgpr_workgroup_id_x 1
.end_amdhsa_kernel
```
